```python
import torch

def _softmax(x, axis=-1):
    return torch.softmax(x, dim=axis)
def _gelu(x):
    return torch.nn.functional.gelu(x, approximate="tanh")
def _silu(x):
    return torch.nn.functional.silu(x)
def _sigmoid(x):
    return torch.sigmoid(x)
def _layernorm(x, axis=-1, eps=1e-5):
    m = x.mean(dim=axis, keepdim=True)
    v = x.var(dim=axis, keepdim=True, unbiased=False)
    return (x - m) / torch.sqrt(v + eps)
def _scatter_add(tgt, idx, src, axis=0):
    return tgt.clone().index_add_(axis, idx, src)
def _segment_sum(src, seg, n):
    out = torch.zeros((n,) + src.shape[1:], dtype=src.dtype)
    return out.index_add_(0, seg, src)
def _pad(x, pw):
    flat = tuple(v for pair in reversed(pw) for v in pair)
    return torch.nn.functional.pad(x, flat)

kernel_name = 'recurrent_scan__mha_block_cached__glu_gated_reglu__decode'

def setup_inputs():

    _w = (lambda a: (lambda t: t.to(torch.bfloat16) if t.is_floating_point() else t)(torch.as_tensor(a)))
    def _A_setup():
        B, Sq, D = 1, 1, 640
        H, Sk, Dh = 32, 32768, 192
        return {
            "x": _w((lambda *s: torch.randn(*s, dtype=torch.bfloat16) * 0.4)(B, Sq, D)),
            "k_cache": _w((lambda *s: torch.randn(*s, dtype=torch.bfloat16) * 1.6)(B, H, Sk, Dh)),
            "v_cache": _w((lambda *s: torch.randn(*s, dtype=torch.bfloat16) * 1.6)(B, H, Sk, Dh)),
            "wq": _w((lambda *s: torch.randn(*s, dtype=torch.bfloat16) * 1.6)(D, H * Dh) * (D ** -0.5)),
            "wo": _w((lambda *s: torch.randn(*s, dtype=torch.bfloat16) * 1.6)(H * Dh, D) * ((H * Dh) ** -0.5)),
        }
    _A_in = _A_setup()

    def _B_setup():
        B, S, D, F = 1, 1, 640, 1536
        return {
            "x": _w((lambda *s: torch.randn(*s, dtype=torch.bfloat16) * 0.4)(B, S, D)),
            "W_gate": _w((lambda *s: torch.randn(*s, dtype=torch.bfloat16) * 1.6)(D, F) * (2.0 / D) ** 0.5),
            "W_up": _w((lambda *s: torch.randn(*s, dtype=torch.bfloat16) * 1.6)(D, F) * (2.0 / D) ** 0.5),
            "W_down": _w((lambda *s: torch.randn(*s, dtype=torch.bfloat16) * 1.6)(F, D) * (1.0 / F) ** 0.5),
        }
    _B_in = _B_setup()

    return {
        "A_x": _A_in["x"],
        "A_k_cache": _A_in["k_cache"],
        "A_v_cache": _A_in["v_cache"],
        "A_wq": _A_in["wq"],
        "A_wo": _A_in["wo"],
        "B_x": _B_in["x"],
        "B_W_gate": _B_in["W_gate"],
        "B_W_up": _B_in["W_up"],
        "B_W_down": _B_in["W_down"],
    }

def reference(A_x, A_k_cache, A_v_cache, A_wq, A_wo, B_x, B_W_gate, B_W_up, B_W_down):
    def _A_ref(x, k_cache, v_cache, wq, wo):
        B, Sq, D = x.shape
        H, Dh = 32, 192
        q = (lambda x, *d: x.permute(*d))((x @ wq).reshape(B, Sq, H, Dh), 0, 2, 1, 3)
        scores = torch.einsum("bhqd,bhkd->bhqk", q, k_cache) * (Dh ** -0.5)
        p = _softmax(scores, axis=-1)
        o = torch.einsum("bhqk,bhkd->bhqd", p, v_cache)
        return (lambda x, *d: x.permute(*d))(o, 0, 2, 1, 3).reshape(B, Sq, H * Dh) @ wo

    def _B_ref(x, W_gate, W_up, W_down):
        gate = torch.einsum("bsd,df->bsf", x, W_gate)
        up = torch.einsum("bsd,df->bsf", x, W_up)
        gate = gate * (lambda x, dt: x.to(dt))(gate > 0, gate.dtype)
        h = gate * up
        return torch.einsum("bsf,fd->bsd", h, W_down)

    x = A_x
    xn = _layernorm(x, axis=-1)
    s = _A_ref(xn, A_k_cache, A_v_cache, A_wq, A_wo)
    g = _silu(_B_ref(xn, B_W_gate, B_W_up, B_W_down))
    return x + s * g
```

```asm
; @launch grid=(256,1,1) block=(256,1,1) lds=60032
.amdgcn_target "amdgcn-amd-amdhsa--gfx950"
.text
.globl recurrent_scan__mha_block_cached__glu_gated_reglu__decode_kernel
.p2align 8
.type recurrent_scan__mha_block_cached__glu_gated_reglu__decode_kernel,@function
recurrent_scan__mha_block_cached__glu_gated_reglu__decode_kernel:
    s_cmp_ge_u32 s2, 256
    s_cbranch_scc1 L_end
    s_load_dwordx8 s[8:15], s[0:1], 0
    s_load_dwordx8 s[16:23], s[0:1], 32
    s_load_dwordx8 s[24:31], s[0:1], 64
    s_getpc_b64 s[4:5]
L_pc:
    v_lshlrev_b32 v22, 7, v0
    v_min_u32 v22, L_code_end-L_pc-4, v22
    v_mov_b32 v23, s5
    v_add_co_u32 v22, vcc, s4, v22
    s_nop 1
    v_addc_co_u32 v23, vcc, 0, v23, vcc
    global_load_dword v23, v[22:23], off
    v_lshrrev_b32 v10, 6, v0
    v_and_b32 v1, 63, v0
    v_readfirstlane_b32 s52, v10
    s_lshr_b32 s53, s2, 3
    s_and_b32 s54, s2, 7
    s_lshl_b32 s74, s53, 3
    s_add_u32 s74, s74, s54
    v_lshrrev_b32 v10, 3, v1
    v_and_b32 v11, 7, v1
    v_mul_u32_u24 v12, 1536, v10
    v_lshl_add_u32 v2, v11, 4, v12
    v_mov_b32 v3, 0
    s_mov_b32 s98, 0
    s_mov_b32 s55, 0
    s_mov_b32 s64, 0x3d93cd3a
    s_mov_b32 s65, 0x3fb8aa3b
    s_mov_b32 s66, 0xffff0000
    s_mul_i32 s57, s53, 12582912
    s_lshl_b32 s60, s53, 8
    s_add_u32 s60, s60, 4096
    s_lshl_b32 s56, s54, 2
    s_add_u32 s56, s56, s52
    s_mov_b32 s100, 32
    s_add_u32 s7, s56, 640
    s_mov_b32 s101, 1600
    s_mov_b32 s3, 25
    s_cmp_ge_u32 s53, 24
    s_cbranch_scc1 L_sched_done
    s_mov_b32 s100, 28
    s_mov_b32 s101, 1560
    s_and_b32 s67, s53, 7
    s_cmp_gt_u32 s54, s67
    s_cselect_b32 s68, 4, 0
    s_sub_u32 s7, s7, s68
    s_cmp_eq_u32 s54, s67
    s_cselect_b32 s3, 20, 25
L_sched_done:
    v_mul_u32_u24 v6, 12288, v10
    v_lshl_add_u32 v6, v11, 4, v6
    v_lshlrev_b32 v7, 2, v1
    s_mul_i32 s67, s54, 983040
    s_mul_i32 s68, s53, 384
    s_add_u32 s67, s67, s68
    s_mul_i32 s58, s56, 12288
    s_add_u32 s58, s58, s57
    s_add_u32 s59, s58, 768
    s_waitcnt lgkmcnt(0)
    s_load_dwordx2 s[62:63], s[30:31], 0
    s_mov_b32 s61, 0
    s_cmp_lg_u32 s52, 0
    s_cbranch_scc1 L_pref
    s_mov_b32 s48, s14
    s_and_b32 s49, s15, 0xffff
    s_mov_b32 s50, 7864320
    s_mov_b32 s51, 0x20000
    s_mov_b32 s44, s8
    s_and_b32 s45, s9, 0xffff
    s_mov_b32 s46, 1280
    s_mov_b32 s47, 0x20000
    buffer_load_dword v180, v7, s[44:47], 0 offen offset:0
    buffer_load_dword v181, v7, s[44:47], 0 offen offset:256
    buffer_load_dword v182, v7, s[44:47], 0 offen offset:512
    buffer_load_dword v183, v7, s[44:47], 0 offen offset:768
    buffer_load_dword v184, v7, s[44:47], 0 offen offset:1024
    buffer_load_dwordx4 v[60:63], v6, s[48:51], s67 offen offset:0 nt
    buffer_load_dwordx4 v[64:67], v6, s[48:51], s67 offen offset:128 nt
    buffer_load_dwordx4 v[68:71], v6, s[48:51], s67 offen offset:256 nt
    s_add_u32 s67, s67, 98304
    buffer_load_dwordx4 v[72:75], v6, s[48:51], s67 offen offset:0 nt
    buffer_load_dwordx4 v[76:79], v6, s[48:51], s67 offen offset:128 nt
    buffer_load_dwordx4 v[80:83], v6, s[48:51], s67 offen offset:256 nt
    s_add_u32 s67, s67, 98304
    buffer_load_dwordx4 v[84:87], v6, s[48:51], s67 offen offset:0 nt
    buffer_load_dwordx4 v[88:91], v6, s[48:51], s67 offen offset:128 nt
    buffer_load_dwordx4 v[92:95], v6, s[48:51], s67 offen offset:256 nt
    s_add_u32 s67, s67, 98304
    buffer_load_dwordx4 v[96:99], v6, s[48:51], s67 offen offset:0 nt
    buffer_load_dwordx4 v[100:103], v6, s[48:51], s67 offen offset:128 nt
    buffer_load_dwordx4 v[104:107], v6, s[48:51], s67 offen offset:256 nt
    s_add_u32 s67, s67, 98304
    buffer_load_dwordx4 v[108:111], v6, s[48:51], s67 offen offset:0 nt
    buffer_load_dwordx4 v[112:115], v6, s[48:51], s67 offen offset:128 nt
    buffer_load_dwordx4 v[116:119], v6, s[48:51], s67 offen offset:256 nt
    s_add_u32 s67, s67, 98304
    buffer_load_dwordx4 v[120:123], v6, s[48:51], s67 offen offset:0 nt
    buffer_load_dwordx4 v[124:127], v6, s[48:51], s67 offen offset:128 nt
    buffer_load_dwordx4 v[128:131], v6, s[48:51], s67 offen offset:256 nt
    s_add_u32 s67, s67, 98304
    buffer_load_dwordx4 v[132:135], v6, s[48:51], s67 offen offset:0 nt
    buffer_load_dwordx4 v[136:139], v6, s[48:51], s67 offen offset:128 nt
    buffer_load_dwordx4 v[140:143], v6, s[48:51], s67 offen offset:256 nt
    s_add_u32 s67, s67, 98304
    buffer_load_dwordx4 v[144:147], v6, s[48:51], s67 offen offset:0 nt
    buffer_load_dwordx4 v[148:151], v6, s[48:51], s67 offen offset:128 nt
    buffer_load_dwordx4 v[152:155], v6, s[48:51], s67 offen offset:256 nt
    s_add_u32 s67, s67, 98304
    buffer_load_dwordx4 v[156:159], v6, s[48:51], s67 offen offset:0 nt
    buffer_load_dwordx4 v[160:163], v6, s[48:51], s67 offen offset:128 nt
    buffer_load_dwordx4 v[164:167], v6, s[48:51], s67 offen offset:256 nt
    s_add_u32 s67, s67, 98304
    buffer_load_dwordx4 v[168:171], v6, s[48:51], s67 offen offset:0 nt
    buffer_load_dwordx4 v[172:175], v6, s[48:51], s67 offen offset:128 nt
    buffer_load_dwordx4 v[176:179], v6, s[48:51], s67 offen offset:256 nt
    s_barrier
    s_mov_b32 s32, s10
    s_and_b32 s33, s11, 0xffff
    s_mov_b32 s34, 402653184
    s_mov_b32 s35, 0x20000
    s_mov_b32 s36, s12
    s_and_b32 s37, s13, 0xffff
    s_mov_b32 s38, 402653184
    s_mov_b32 s39, 0x20000
    s_mov_b32 s40, s30
    s_and_b32 s41, s31, 0xffff
    s_mov_b32 s42, 3145728
    s_mov_b32 s43, 0x20000
    s_cmp_lg_u32 s54, 0
    s_cbranch_scc1 L_noz
    s_mov_b64 exec, 1
    buffer_store_dword v3, v3, s[40:43], s60 offen sc1
    s_mov_b64 exec, -1
L_noz:
    v_and_b32 v11, 7, v1
    v_lshrrev_b32 v12, 4, v1
    v_and_b32 v13, 1, v12
    v_mul_u32_u24 v13, 12, v13
    v_lshrrev_b32 v12, 1, v12
    v_mad_u32_u24 v13, v12, 6, v13
    v_add_u32 v12, 0, v13
    v_lshrrev_b32 v16, 3, v12
    v_lshlrev_b32 v16, 8, v16
    v_and_b32 v12, 7, v12
    v_lshl_add_u32 v16, v12, 2, v16
    v_lshl_add_u32 v16, v11, 5, v16
    v_add_u32 v12, 1, v13
    v_lshrrev_b32 v17, 3, v12
    v_lshlrev_b32 v17, 8, v17
    v_and_b32 v12, 7, v12
    v_lshl_add_u32 v17, v12, 2, v17
    v_lshl_add_u32 v17, v11, 5, v17
    v_add_u32 v12, 2, v13
    v_lshrrev_b32 v18, 3, v12
    v_lshlrev_b32 v18, 8, v18
    v_and_b32 v12, 7, v12
    v_lshl_add_u32 v18, v12, 2, v18
    v_lshl_add_u32 v18, v11, 5, v18
    v_add_u32 v12, 3, v13
    v_lshrrev_b32 v19, 3, v12
    v_lshlrev_b32 v19, 8, v19
    v_and_b32 v12, 7, v12
    v_lshl_add_u32 v19, v12, 2, v19
    v_lshl_add_u32 v19, v11, 5, v19
    v_add_u32 v12, 4, v13
    v_lshrrev_b32 v20, 3, v12
    v_lshlrev_b32 v20, 8, v20
    v_and_b32 v12, 7, v12
    v_lshl_add_u32 v20, v12, 2, v20
    v_lshl_add_u32 v20, v11, 5, v20
    v_add_u32 v12, 5, v13
    v_lshrrev_b32 v21, 3, v12
    v_lshlrev_b32 v21, 8, v21
    v_and_b32 v12, 7, v12
    v_lshl_add_u32 v21, v12, 2, v21
    v_lshl_add_u32 v21, v11, 5, v21
    v_mov_b32 v36, 0
    v_mov_b32 v37, 0
    v_mov_b32 v38, 0
    v_mov_b32 v39, 0
    v_mov_b32 v40, 0
    v_mov_b32 v41, 0
    v_mov_b32 v42, 0
    v_mov_b32 v43, 0
    v_mov_b32 v44, 0
    v_mov_b32 v45, 0
    v_mov_b32 v46, 0
    v_mov_b32 v47, 0
    v_mov_b32 v48, 0
    v_mov_b32 v49, 0
    v_mov_b32 v50, 0
    v_mov_b32 v51, 0
    v_mov_b32 v52, 0
    v_mov_b32 v53, 0
    v_mov_b32 v54, 0
    v_mov_b32 v55, 0
    v_mov_b32 v56, 0
    v_mov_b32 v57, 0
    v_mov_b32 v58, 0
    v_mov_b32 v59, 0
    s_waitcnt vmcnt(30)
    v_lshlrev_b32 v186, 16, v180
    v_and_b32 v187, s66, v180
    v_lshlrev_b32 v188, 16, v181
    v_and_b32 v189, s66, v181
    v_lshlrev_b32 v190, 16, v182
    v_and_b32 v191, s66, v182
    v_lshlrev_b32 v192, 16, v183
    v_and_b32 v193, s66, v183
    v_lshlrev_b32 v194, 16, v184
    v_and_b32 v195, s66, v184
    v_add_f32 v196, v186, v187
    v_add_f32 v196, v196, v188
    v_add_f32 v196, v196, v189
    v_add_f32 v196, v196, v190
    v_add_f32 v196, v196, v191
    v_add_f32 v196, v196, v192
    v_add_f32 v196, v196, v193
    v_add_f32 v196, v196, v194
    v_add_f32 v196, v196, v195
    s_nop 1
    v_add_f32_dpp v196, v196, v196 quad_perm:[1,0,3,2] row_mask:0xf bank_mask:0xf
    s_nop 1
    v_add_f32_dpp v196, v196, v196 quad_perm:[2,3,0,1] row_mask:0xf bank_mask:0xf
    s_nop 1
    v_add_f32_dpp v196, v196, v196 row_half_mirror row_mask:0xf bank_mask:0xf
    s_nop 1
    v_add_f32_dpp v196, v196, v196 row_mirror row_mask:0xf bank_mask:0xf
    v_mov_b32 v197, v196
    s_nop 1
    v_permlane16_swap_b32 v196, v197
    v_add_f32 v196, v196, v197
    v_mov_b32 v197, v196
    s_nop 1
    v_permlane32_swap_b32 v196, v197
    v_add_f32 v196, v196, v197
    v_mul_f32 v196, 0x3acccccd, v196
    v_sub_f32 v198, v186, v196
    v_mul_f32 v199, v198, v198
    v_sub_f32 v198, v187, v196
    v_fmac_f32 v199, v198, v198
    v_sub_f32 v198, v188, v196
    v_fmac_f32 v199, v198, v198
    v_sub_f32 v198, v189, v196
    v_fmac_f32 v199, v198, v198
    v_sub_f32 v198, v190, v196
    v_fmac_f32 v199, v198, v198
    v_sub_f32 v198, v191, v196
    v_fmac_f32 v199, v198, v198
    v_sub_f32 v198, v192, v196
    v_fmac_f32 v199, v198, v198
    v_sub_f32 v198, v193, v196
    v_fmac_f32 v199, v198, v198
    v_sub_f32 v198, v194, v196
    v_fmac_f32 v199, v198, v198
    v_sub_f32 v198, v195, v196
    v_fmac_f32 v199, v198, v198
    s_nop 1
    v_add_f32_dpp v199, v199, v199 quad_perm:[1,0,3,2] row_mask:0xf bank_mask:0xf
    s_nop 1
    v_add_f32_dpp v199, v199, v199 quad_perm:[2,3,0,1] row_mask:0xf bank_mask:0xf
    s_nop 1
    v_add_f32_dpp v199, v199, v199 row_half_mirror row_mask:0xf bank_mask:0xf
    s_nop 1
    v_add_f32_dpp v199, v199, v199 row_mirror row_mask:0xf bank_mask:0xf
    v_mov_b32 v197, v199
    s_nop 1
    v_permlane16_swap_b32 v199, v197
    v_add_f32 v199, v199, v197
    v_mov_b32 v197, v199
    s_nop 1
    v_permlane32_swap_b32 v199, v197
    v_add_f32 v199, v199, v197
    v_mul_f32 v199, 0x3acccccd, v199
    v_cvt_pk_bf16_f32 v196, v196, v196
    v_and_b32 v196, s66, v196
    v_cvt_pk_bf16_f32 v199, v199, v199
    v_and_b32 v199, s66, v199
    v_add_f32 v199, 0x3727c5ac, v199
    v_cvt_pk_bf16_f32 v199, v199, v199
    v_and_b32 v199, s66, v199
    v_sqrt_f32 v199, v199
    s_nop 0
    v_cvt_pk_bf16_f32 v199, v199, v199
    v_and_b32 v199, s66, v199
    v_rcp_f32 v200, v199
    v_sub_f32 v186, v186, v196
    v_sub_f32 v187, v187, v196
    v_sub_f32 v188, v188, v196
    v_sub_f32 v189, v189, v196
    v_sub_f32 v190, v190, v196
    v_sub_f32 v191, v191, v196
    v_sub_f32 v192, v192, v196
    v_sub_f32 v193, v193, v196
    v_sub_f32 v194, v194, v196
    v_sub_f32 v195, v195, v196
    v_cvt_pk_bf16_f32 v197, v186, v187
    v_lshlrev_b32 v186, 16, v197
    v_and_b32 v187, s66, v197
    v_cvt_pk_bf16_f32 v197, v188, v189
    v_lshlrev_b32 v188, 16, v197
    v_and_b32 v189, s66, v197
    v_cvt_pk_bf16_f32 v197, v190, v191
    v_lshlrev_b32 v190, 16, v197
    v_and_b32 v191, s66, v197
    v_cvt_pk_bf16_f32 v197, v192, v193
    v_lshlrev_b32 v192, 16, v197
    v_and_b32 v193, s66, v197
    v_cvt_pk_bf16_f32 v197, v194, v195
    v_lshlrev_b32 v194, 16, v197
    v_and_b32 v195, s66, v197
    v_mul_f32 v197, v186, v200
    v_fma_f32 v198, -v197, v199, v186
    v_fma_f32 v186, v198, v200, v197
    v_mul_f32 v197, v187, v200
    v_fma_f32 v198, -v197, v199, v187
    v_fma_f32 v187, v198, v200, v197
    v_mul_f32 v197, v188, v200
    v_fma_f32 v198, -v197, v199, v188
    v_fma_f32 v188, v198, v200, v197
    v_mul_f32 v197, v189, v200
    v_fma_f32 v198, -v197, v199, v189
    v_fma_f32 v189, v198, v200, v197
    v_mul_f32 v197, v190, v200
    v_fma_f32 v198, -v197, v199, v190
    v_fma_f32 v190, v198, v200, v197
    v_mul_f32 v197, v191, v200
    v_fma_f32 v198, -v197, v199, v191
    v_fma_f32 v191, v198, v200, v197
    v_mul_f32 v197, v192, v200
    v_fma_f32 v198, -v197, v199, v192
    v_fma_f32 v192, v198, v200, v197
    v_mul_f32 v197, v193, v200
    v_fma_f32 v198, -v197, v199, v193
    v_fma_f32 v193, v198, v200, v197
    v_mul_f32 v197, v194, v200
    v_fma_f32 v198, -v197, v199, v194
    v_fma_f32 v194, v198, v200, v197
    v_mul_f32 v197, v195, v200
    v_fma_f32 v198, -v197, v199, v195
    v_fma_f32 v195, v198, v200, v197
    v_cvt_pk_bf16_f32 v197, v186, v187
    v_lshlrev_b32 v186, 16, v197
    v_and_b32 v187, s66, v197
    v_cvt_pk_bf16_f32 v197, v188, v189
    v_lshlrev_b32 v188, 16, v197
    v_and_b32 v189, s66, v197
    v_cvt_pk_bf16_f32 v197, v190, v191
    v_lshlrev_b32 v190, 16, v197
    v_and_b32 v191, s66, v197
    v_cvt_pk_bf16_f32 v197, v192, v193
    v_lshlrev_b32 v192, 16, v197
    v_and_b32 v193, s66, v197
    v_cvt_pk_bf16_f32 v197, v194, v195
    v_lshlrev_b32 v194, 16, v197
    v_and_b32 v195, s66, v197
    v_lshlrev_b32 v197, 3, v1
    ds_write_b64 v197, v[186:187] offset:0
    ds_write_b64 v197, v[188:189] offset:512
    ds_write_b64 v197, v[190:191] offset:1024
    ds_write_b64 v197, v[192:193] offset:1536
    ds_write_b64 v197, v[194:195] offset:2048
    s_mul_i32 s68, s54, 320
    v_lshrrev_b32 v196, 3, v1
    v_lshl_add_u32 v196, v196, 2, s68
    ds_read_b32 v204, v196 offset:0
    ds_read_b32 v206, v196 offset:32
    ds_read_b32 v208, v196 offset:64
    ds_read_b32 v210, v196 offset:96
    ds_read_b32 v212, v196 offset:128
    ds_read_b32 v214, v196 offset:160
    ds_read_b32 v216, v196 offset:192
    ds_read_b32 v218, v196 offset:224
    ds_read_b32 v220, v196 offset:256
    ds_read_b32 v222, v196 offset:288
    s_waitcnt lgkmcnt(0)
    v_lshrrev_b32 v205, 16, v204
    v_lshrrev_b32 v207, 16, v206
    v_lshrrev_b32 v209, 16, v208
    v_lshrrev_b32 v211, 16, v210
    v_lshrrev_b32 v213, 16, v212
    v_lshrrev_b32 v215, 16, v214
    v_lshrrev_b32 v217, 16, v216
    v_lshrrev_b32 v219, 16, v218
    v_lshrrev_b32 v221, 16, v220
    v_lshrrev_b32 v223, 16, v222
    s_add_u32 s62, s62, 0x7F4A7C15
    s_addc_u32 s63, s63, 0x9E3779B9
    s_waitcnt vmcnt(27)
    v_dot2c_f32_bf16 v36, v60, v205
    v_dot2c_f32_bf16 v37, v60, v204
    v_dot2c_f32_bf16 v38, v61, v205
    v_dot2c_f32_bf16 v39, v61, v204
    v_dot2c_f32_bf16 v40, v62, v205
    v_dot2c_f32_bf16 v41, v62, v204
    v_dot2c_f32_bf16 v42, v63, v205
    v_dot2c_f32_bf16 v43, v63, v204
    v_dot2c_f32_bf16 v44, v64, v205
    v_dot2c_f32_bf16 v45, v64, v204
    v_dot2c_f32_bf16 v46, v65, v205
    v_dot2c_f32_bf16 v47, v65, v204
    v_dot2c_f32_bf16 v48, v66, v205
    v_dot2c_f32_bf16 v49, v66, v204
    v_dot2c_f32_bf16 v50, v67, v205
    v_dot2c_f32_bf16 v51, v67, v204
    v_dot2c_f32_bf16 v52, v68, v205
    v_dot2c_f32_bf16 v53, v68, v204
    v_dot2c_f32_bf16 v54, v69, v205
    v_dot2c_f32_bf16 v55, v69, v204
    v_dot2c_f32_bf16 v56, v70, v205
    v_dot2c_f32_bf16 v57, v70, v204
    v_dot2c_f32_bf16 v58, v71, v205
    v_dot2c_f32_bf16 v59, v71, v204
    s_waitcnt vmcnt(24)
    v_dot2c_f32_bf16 v36, v72, v207
    v_dot2c_f32_bf16 v37, v72, v206
    v_dot2c_f32_bf16 v38, v73, v207
    v_dot2c_f32_bf16 v39, v73, v206
    v_dot2c_f32_bf16 v40, v74, v207
    v_dot2c_f32_bf16 v41, v74, v206
    v_dot2c_f32_bf16 v42, v75, v207
    v_dot2c_f32_bf16 v43, v75, v206
    v_dot2c_f32_bf16 v44, v76, v207
    v_dot2c_f32_bf16 v45, v76, v206
    v_dot2c_f32_bf16 v46, v77, v207
    v_dot2c_f32_bf16 v47, v77, v206
    v_dot2c_f32_bf16 v48, v78, v207
    v_dot2c_f32_bf16 v49, v78, v206
    v_dot2c_f32_bf16 v50, v79, v207
    v_dot2c_f32_bf16 v51, v79, v206
    v_dot2c_f32_bf16 v52, v80, v207
    v_dot2c_f32_bf16 v53, v80, v206
    v_dot2c_f32_bf16 v54, v81, v207
    v_dot2c_f32_bf16 v55, v81, v206
    v_dot2c_f32_bf16 v56, v82, v207
    v_dot2c_f32_bf16 v57, v82, v206
    v_dot2c_f32_bf16 v58, v83, v207
    v_dot2c_f32_bf16 v59, v83, v206
    s_waitcnt vmcnt(21)
    v_dot2c_f32_bf16 v36, v84, v209
    v_dot2c_f32_bf16 v37, v84, v208
    v_dot2c_f32_bf16 v38, v85, v209
    v_dot2c_f32_bf16 v39, v85, v208
    v_dot2c_f32_bf16 v40, v86, v209
    v_dot2c_f32_bf16 v41, v86, v208
    v_dot2c_f32_bf16 v42, v87, v209
    v_dot2c_f32_bf16 v43, v87, v208
    v_dot2c_f32_bf16 v44, v88, v209
    v_dot2c_f32_bf16 v45, v88, v208
    v_dot2c_f32_bf16 v46, v89, v209
    v_dot2c_f32_bf16 v47, v89, v208
    v_dot2c_f32_bf16 v48, v90, v209
    v_dot2c_f32_bf16 v49, v90, v208
    v_dot2c_f32_bf16 v50, v91, v209
    v_dot2c_f32_bf16 v51, v91, v208
    v_dot2c_f32_bf16 v52, v92, v209
    v_dot2c_f32_bf16 v53, v92, v208
    v_dot2c_f32_bf16 v54, v93, v209
    v_dot2c_f32_bf16 v55, v93, v208
    v_dot2c_f32_bf16 v56, v94, v209
    v_dot2c_f32_bf16 v57, v94, v208
    v_dot2c_f32_bf16 v58, v95, v209
    v_dot2c_f32_bf16 v59, v95, v208
    s_waitcnt vmcnt(18)
    v_dot2c_f32_bf16 v36, v96, v211
    v_dot2c_f32_bf16 v37, v96, v210
    v_dot2c_f32_bf16 v38, v97, v211
    v_dot2c_f32_bf16 v39, v97, v210
    v_dot2c_f32_bf16 v40, v98, v211
    v_dot2c_f32_bf16 v41, v98, v210
    v_dot2c_f32_bf16 v42, v99, v211
    v_dot2c_f32_bf16 v43, v99, v210
    v_dot2c_f32_bf16 v44, v100, v211
    v_dot2c_f32_bf16 v45, v100, v210
    v_dot2c_f32_bf16 v46, v101, v211
    v_dot2c_f32_bf16 v47, v101, v210
    v_dot2c_f32_bf16 v48, v102, v211
    v_dot2c_f32_bf16 v49, v102, v210
    v_dot2c_f32_bf16 v50, v103, v211
    v_dot2c_f32_bf16 v51, v103, v210
    v_dot2c_f32_bf16 v52, v104, v211
    v_dot2c_f32_bf16 v53, v104, v210
    v_dot2c_f32_bf16 v54, v105, v211
    v_dot2c_f32_bf16 v55, v105, v210
    v_dot2c_f32_bf16 v56, v106, v211
    v_dot2c_f32_bf16 v57, v106, v210
    v_dot2c_f32_bf16 v58, v107, v211
    v_dot2c_f32_bf16 v59, v107, v210
    s_waitcnt vmcnt(15)
    v_dot2c_f32_bf16 v36, v108, v213
    v_dot2c_f32_bf16 v37, v108, v212
    v_dot2c_f32_bf16 v38, v109, v213
    v_dot2c_f32_bf16 v39, v109, v212
    v_dot2c_f32_bf16 v40, v110, v213
    v_dot2c_f32_bf16 v41, v110, v212
    v_dot2c_f32_bf16 v42, v111, v213
    v_dot2c_f32_bf16 v43, v111, v212
    v_dot2c_f32_bf16 v44, v112, v213
    v_dot2c_f32_bf16 v45, v112, v212
    v_dot2c_f32_bf16 v46, v113, v213
    v_dot2c_f32_bf16 v47, v113, v212
    v_dot2c_f32_bf16 v48, v114, v213
    v_dot2c_f32_bf16 v49, v114, v212
    v_dot2c_f32_bf16 v50, v115, v213
    v_dot2c_f32_bf16 v51, v115, v212
    v_dot2c_f32_bf16 v52, v116, v213
    v_dot2c_f32_bf16 v53, v116, v212
    v_dot2c_f32_bf16 v54, v117, v213
    v_dot2c_f32_bf16 v55, v117, v212
    v_dot2c_f32_bf16 v56, v118, v213
    v_dot2c_f32_bf16 v57, v118, v212
    v_dot2c_f32_bf16 v58, v119, v213
    v_dot2c_f32_bf16 v59, v119, v212
    s_waitcnt vmcnt(12)
    v_dot2c_f32_bf16 v36, v120, v215
    v_dot2c_f32_bf16 v37, v120, v214
    v_dot2c_f32_bf16 v38, v121, v215
    v_dot2c_f32_bf16 v39, v121, v214
    v_dot2c_f32_bf16 v40, v122, v215
    v_dot2c_f32_bf16 v41, v122, v214
    v_dot2c_f32_bf16 v42, v123, v215
    v_dot2c_f32_bf16 v43, v123, v214
    v_dot2c_f32_bf16 v44, v124, v215
    v_dot2c_f32_bf16 v45, v124, v214
    v_dot2c_f32_bf16 v46, v125, v215
    v_dot2c_f32_bf16 v47, v125, v214
    v_dot2c_f32_bf16 v48, v126, v215
    v_dot2c_f32_bf16 v49, v126, v214
    v_dot2c_f32_bf16 v50, v127, v215
    v_dot2c_f32_bf16 v51, v127, v214
    v_dot2c_f32_bf16 v52, v128, v215
    v_dot2c_f32_bf16 v53, v128, v214
    v_dot2c_f32_bf16 v54, v129, v215
    v_dot2c_f32_bf16 v55, v129, v214
    v_dot2c_f32_bf16 v56, v130, v215
    v_dot2c_f32_bf16 v57, v130, v214
    v_dot2c_f32_bf16 v58, v131, v215
    v_dot2c_f32_bf16 v59, v131, v214
    s_waitcnt vmcnt(9)
    v_dot2c_f32_bf16 v36, v132, v217
    v_dot2c_f32_bf16 v37, v132, v216
    v_dot2c_f32_bf16 v38, v133, v217
    v_dot2c_f32_bf16 v39, v133, v216
    v_dot2c_f32_bf16 v40, v134, v217
    v_dot2c_f32_bf16 v41, v134, v216
    v_dot2c_f32_bf16 v42, v135, v217
    v_dot2c_f32_bf16 v43, v135, v216
    v_dot2c_f32_bf16 v44, v136, v217
    v_dot2c_f32_bf16 v45, v136, v216
    v_dot2c_f32_bf16 v46, v137, v217
    v_dot2c_f32_bf16 v47, v137, v216
    v_dot2c_f32_bf16 v48, v138, v217
    v_dot2c_f32_bf16 v49, v138, v216
    v_dot2c_f32_bf16 v50, v139, v217
    v_dot2c_f32_bf16 v51, v139, v216
    v_dot2c_f32_bf16 v52, v140, v217
    v_dot2c_f32_bf16 v53, v140, v216
    v_dot2c_f32_bf16 v54, v141, v217
    v_dot2c_f32_bf16 v55, v141, v216
    v_dot2c_f32_bf16 v56, v142, v217
    v_dot2c_f32_bf16 v57, v142, v216
    v_dot2c_f32_bf16 v58, v143, v217
    v_dot2c_f32_bf16 v59, v143, v216
    s_waitcnt vmcnt(6)
    v_dot2c_f32_bf16 v36, v144, v219
    v_dot2c_f32_bf16 v37, v144, v218
    v_dot2c_f32_bf16 v38, v145, v219
    v_dot2c_f32_bf16 v39, v145, v218
    v_dot2c_f32_bf16 v40, v146, v219
    v_dot2c_f32_bf16 v41, v146, v218
    v_dot2c_f32_bf16 v42, v147, v219
    v_dot2c_f32_bf16 v43, v147, v218
    v_dot2c_f32_bf16 v44, v148, v219
    v_dot2c_f32_bf16 v45, v148, v218
    v_dot2c_f32_bf16 v46, v149, v219
    v_dot2c_f32_bf16 v47, v149, v218
    v_dot2c_f32_bf16 v48, v150, v219
    v_dot2c_f32_bf16 v49, v150, v218
    v_dot2c_f32_bf16 v50, v151, v219
    v_dot2c_f32_bf16 v51, v151, v218
    v_dot2c_f32_bf16 v52, v152, v219
    v_dot2c_f32_bf16 v53, v152, v218
    v_dot2c_f32_bf16 v54, v153, v219
    v_dot2c_f32_bf16 v55, v153, v218
    v_dot2c_f32_bf16 v56, v154, v219
    v_dot2c_f32_bf16 v57, v154, v218
    v_dot2c_f32_bf16 v58, v155, v219
    v_dot2c_f32_bf16 v59, v155, v218
    s_waitcnt vmcnt(3)
    v_dot2c_f32_bf16 v36, v156, v221
    v_dot2c_f32_bf16 v37, v156, v220
    v_dot2c_f32_bf16 v38, v157, v221
    v_dot2c_f32_bf16 v39, v157, v220
    v_dot2c_f32_bf16 v40, v158, v221
    v_dot2c_f32_bf16 v41, v158, v220
    v_dot2c_f32_bf16 v42, v159, v221
    v_dot2c_f32_bf16 v43, v159, v220
    v_dot2c_f32_bf16 v44, v160, v221
    v_dot2c_f32_bf16 v45, v160, v220
    v_dot2c_f32_bf16 v46, v161, v221
    v_dot2c_f32_bf16 v47, v161, v220
    v_dot2c_f32_bf16 v48, v162, v221
    v_dot2c_f32_bf16 v49, v162, v220
    v_dot2c_f32_bf16 v50, v163, v221
    v_dot2c_f32_bf16 v51, v163, v220
    v_dot2c_f32_bf16 v52, v164, v221
    v_dot2c_f32_bf16 v53, v164, v220
    v_dot2c_f32_bf16 v54, v165, v221
    v_dot2c_f32_bf16 v55, v165, v220
    v_dot2c_f32_bf16 v56, v166, v221
    v_dot2c_f32_bf16 v57, v166, v220
    v_dot2c_f32_bf16 v58, v167, v221
    v_dot2c_f32_bf16 v59, v167, v220
    s_waitcnt vmcnt(0)
    v_dot2c_f32_bf16 v36, v168, v223
    v_dot2c_f32_bf16 v37, v168, v222
    v_dot2c_f32_bf16 v38, v169, v223
    v_dot2c_f32_bf16 v39, v169, v222
    v_dot2c_f32_bf16 v40, v170, v223
    v_dot2c_f32_bf16 v41, v170, v222
    v_dot2c_f32_bf16 v42, v171, v223
    v_dot2c_f32_bf16 v43, v171, v222
    v_dot2c_f32_bf16 v44, v172, v223
    v_dot2c_f32_bf16 v45, v172, v222
    v_dot2c_f32_bf16 v46, v173, v223
    v_dot2c_f32_bf16 v47, v173, v222
    v_dot2c_f32_bf16 v48, v174, v223
    v_dot2c_f32_bf16 v49, v174, v222
    v_dot2c_f32_bf16 v50, v175, v223
    v_dot2c_f32_bf16 v51, v175, v222
    v_dot2c_f32_bf16 v52, v176, v223
    v_dot2c_f32_bf16 v53, v176, v222
    v_dot2c_f32_bf16 v54, v177, v223
    v_dot2c_f32_bf16 v55, v177, v222
    v_dot2c_f32_bf16 v56, v178, v223
    v_dot2c_f32_bf16 v57, v178, v222
    v_dot2c_f32_bf16 v58, v179, v223
    v_dot2c_f32_bf16 v59, v179, v222
    v_add_f32_dpp v36, v36, v36 row_ror:8 row_mask:0xf bank_mask:0xf
    v_add_f32_dpp v37, v37, v37 row_ror:8 row_mask:0xf bank_mask:0xf
    v_add_f32_dpp v38, v38, v38 row_ror:8 row_mask:0xf bank_mask:0xf
    v_add_f32_dpp v39, v39, v39 row_ror:8 row_mask:0xf bank_mask:0xf
    v_add_f32_dpp v40, v40, v40 row_ror:8 row_mask:0xf bank_mask:0xf
    v_add_f32_dpp v41, v41, v41 row_ror:8 row_mask:0xf bank_mask:0xf
    v_add_f32_dpp v42, v42, v42 row_ror:8 row_mask:0xf bank_mask:0xf
    v_add_f32_dpp v43, v43, v43 row_ror:8 row_mask:0xf bank_mask:0xf
    v_add_f32_dpp v44, v44, v44 row_ror:8 row_mask:0xf bank_mask:0xf
    v_add_f32_dpp v45, v45, v45 row_ror:8 row_mask:0xf bank_mask:0xf
    v_add_f32_dpp v46, v46, v46 row_ror:8 row_mask:0xf bank_mask:0xf
    v_add_f32_dpp v47, v47, v47 row_ror:8 row_mask:0xf bank_mask:0xf
    v_add_f32_dpp v48, v48, v48 row_ror:8 row_mask:0xf bank_mask:0xf
    v_add_f32_dpp v49, v49, v49 row_ror:8 row_mask:0xf bank_mask:0xf
    v_add_f32_dpp v50, v50, v50 row_ror:8 row_mask:0xf bank_mask:0xf
    v_add_f32_dpp v51, v51, v51 row_ror:8 row_mask:0xf bank_mask:0xf
    v_add_f32_dpp v52, v52, v52 row_ror:8 row_mask:0xf bank_mask:0xf
    v_add_f32_dpp v53, v53, v53 row_ror:8 row_mask:0xf bank_mask:0xf
    v_add_f32_dpp v54, v54, v54 row_ror:8 row_mask:0xf bank_mask:0xf
    v_add_f32_dpp v55, v55, v55 row_ror:8 row_mask:0xf bank_mask:0xf
    v_add_f32_dpp v56, v56, v56 row_ror:8 row_mask:0xf bank_mask:0xf
    v_add_f32_dpp v57, v57, v57 row_ror:8 row_mask:0xf bank_mask:0xf
    v_add_f32_dpp v58, v58, v58 row_ror:8 row_mask:0xf bank_mask:0xf
    v_add_f32_dpp v59, v59, v59 row_ror:8 row_mask:0xf bank_mask:0xf
    v_permlane16_swap_b32 v36, v48
    v_permlane16_swap_b32 v37, v49
    v_permlane16_swap_b32 v38, v50
    v_permlane16_swap_b32 v39, v51
    v_permlane16_swap_b32 v40, v52
    v_permlane16_swap_b32 v41, v53
    v_permlane16_swap_b32 v42, v54
    v_permlane16_swap_b32 v43, v55
    v_permlane16_swap_b32 v44, v56
    v_permlane16_swap_b32 v45, v57
    v_permlane16_swap_b32 v46, v58
    v_permlane16_swap_b32 v47, v59
    v_add_f32 v36, v36, v48
    v_add_f32 v37, v37, v49
    v_add_f32 v38, v38, v50
    v_add_f32 v39, v39, v51
    v_add_f32 v40, v40, v52
    v_add_f32 v41, v41, v53
    v_add_f32 v42, v42, v54
    v_add_f32 v43, v43, v55
    v_add_f32 v44, v44, v56
    v_add_f32 v45, v45, v57
    v_add_f32 v46, v46, v58
    v_add_f32 v47, v47, v59
    v_permlane32_swap_b32 v36, v42
    v_permlane32_swap_b32 v37, v43
    v_permlane32_swap_b32 v38, v44
    v_permlane32_swap_b32 v39, v45
    v_permlane32_swap_b32 v40, v46
    v_permlane32_swap_b32 v41, v47
    v_add_f32 v36, v36, v42
    v_add_f32 v37, v37, v43
    v_add_f32 v38, v38, v44
    v_add_f32 v39, v39, v45
    v_add_f32 v40, v40, v46
    v_add_f32 v41, v41, v47
    v_mov_b32 v224, v36
    v_mov_b32 v225, s62
    v_mov_b32 v226, v37
    v_mov_b32 v227, s63
    v_lshlrev_b32 v236, 1, v16
    v_mov_b32 v228, v38
    v_mov_b32 v229, s62
    v_mov_b32 v230, v39
    v_mov_b32 v231, s63
    v_lshlrev_b32 v237, 1, v18
    v_mov_b32 v232, v40
    v_mov_b32 v233, s62
    v_mov_b32 v234, v41
    v_mov_b32 v235, s63
    v_lshlrev_b32 v238, 1, v20
    s_lshl_b32 s67, s74, 11
    s_add_u32 s67, s67, 65536
    s_mov_b32 exec_lo, 0x00ff00ff
    s_mov_b32 exec_hi, 0x00ff00ff
    buffer_store_dwordx4 v[224:227], v236, s[40:43], s67 offen sc1
    buffer_store_dwordx4 v[228:231], v237, s[40:43], s67 offen sc1
    buffer_store_dwordx4 v[232:235], v238, s[40:43], s67 offen sc1
    s_mov_b64 exec, -1
    v_lshlrev_b32 v250, 5, v1
    s_waitcnt vmcnt(0)
    s_mov_b32 exec_lo, -1
    s_mov_b32 exec_hi, 0xffff
    s_lshl_b32 s68, s53, 14
    s_add_u32 s68, s68, 65536
    buffer_load_dwordx4 v[156:159], v250, s[40:43], s68 offen sc1
    buffer_load_dwordx4 v[160:163], v250, s[40:43], s68 offen offset:16 sc1
    s_add_u32 s68, s68, 2048
    buffer_load_dwordx4 v[164:167], v250, s[40:43], s68 offen sc1
    buffer_load_dwordx4 v[168:171], v250, s[40:43], s68 offen offset:16 sc1
    s_add_u32 s68, s68, 2048
    buffer_load_dwordx4 v[172:175], v250, s[40:43], s68 offen sc1
    buffer_load_dwordx4 v[176:179], v250, s[40:43], s68 offen offset:16 sc1
    s_add_u32 s68, s68, 2048
    buffer_load_dwordx4 v[180:183], v250, s[40:43], s68 offen sc1
    buffer_load_dwordx4 v[184:187], v250, s[40:43], s68 offen offset:16 sc1
    s_add_u32 s68, s68, 2048
    buffer_load_dwordx4 v[188:191], v250, s[40:43], s68 offen sc1
    buffer_load_dwordx4 v[192:195], v250, s[40:43], s68 offen offset:16 sc1
    s_add_u32 s68, s68, 2048
    buffer_load_dwordx4 v[196:199], v250, s[40:43], s68 offen sc1
    buffer_load_dwordx4 v[200:203], v250, s[40:43], s68 offen offset:16 sc1
    s_add_u32 s68, s68, 2048
    buffer_load_dwordx4 v[204:207], v250, s[40:43], s68 offen sc1
    buffer_load_dwordx4 v[208:211], v250, s[40:43], s68 offen offset:16 sc1
    s_add_u32 s68, s68, 2048
    buffer_load_dwordx4 v[212:215], v250, s[40:43], s68 offen sc1
    buffer_load_dwordx4 v[216:219], v250, s[40:43], s68 offen offset:16 sc1
    s_mov_b64 exec, -1
    s_barrier
    buffer_load_dwordx4 v[60:63], v2, s[32:35], s58 offen offset:0 nt
    buffer_load_dwordx4 v[64:67], v2, s[32:35], s58 offen offset:128 nt
    buffer_load_dwordx4 v[68:71], v2, s[32:35], s58 offen offset:256 nt
    buffer_load_dwordx4 v[108:111], v2, s[36:39], s58 offen offset:0 nt
    buffer_load_dwordx4 v[112:115], v2, s[36:39], s58 offen offset:128 nt
    buffer_load_dwordx4 v[116:119], v2, s[36:39], s58 offen offset:256 nt
    buffer_load_dwordx4 v[72:75], v2, s[32:35], s58 offen offset:384 nt
    buffer_load_dwordx4 v[76:79], v2, s[32:35], s58 offen offset:512 nt
    buffer_load_dwordx4 v[80:83], v2, s[32:35], s58 offen offset:640 nt
    buffer_load_dwordx4 v[120:123], v2, s[36:39], s58 offen offset:384 nt
    buffer_load_dwordx4 v[124:127], v2, s[36:39], s58 offen offset:512 nt
    buffer_load_dwordx4 v[128:131], v2, s[36:39], s58 offen offset:640 nt
    buffer_load_dwordx4 v[84:87], v2, s[32:35], s59 offen offset:0 nt
    buffer_load_dwordx4 v[88:91], v2, s[32:35], s59 offen offset:128 nt
    buffer_load_dwordx4 v[92:95], v2, s[32:35], s59 offen offset:256 nt
    buffer_load_dwordx4 v[132:135], v2, s[36:39], s59 offen offset:0 nt
    buffer_load_dwordx4 v[136:139], v2, s[36:39], s59 offen offset:128 nt
    buffer_load_dwordx4 v[140:143], v2, s[36:39], s59 offen offset:256 nt
    buffer_load_dwordx4 v[96:99], v2, s[32:35], s59 offen offset:384 nt
    buffer_load_dwordx4 v[100:103], v2, s[32:35], s59 offen offset:512 nt
    buffer_load_dwordx4 v[104:107], v2, s[32:35], s59 offen offset:640 nt
    buffer_load_dwordx4 v[144:147], v2, s[36:39], s59 offen offset:384 nt
    buffer_load_dwordx4 v[148:151], v2, s[36:39], s59 offen offset:512 nt
    buffer_load_dwordx4 v[152:155], v2, s[36:39], s59 offen offset:640 nt
    s_mov_b32 exec_lo, -1
    s_mov_b32 exec_hi, 0xffff
    s_mov_b32 s73, 524288
    s_waitcnt vmcnt(24)
    s_branch L_poll1_chk
L_poll1:
    s_lshl_b32 s68, s53, 14
    s_add_u32 s68, s68, 65536
    buffer_load_dwordx4 v[156:159], v250, s[40:43], s68 offen sc1
    buffer_load_dwordx4 v[160:163], v250, s[40:43], s68 offen offset:16 sc1
    s_add_u32 s68, s68, 2048
    buffer_load_dwordx4 v[164:167], v250, s[40:43], s68 offen sc1
    buffer_load_dwordx4 v[168:171], v250, s[40:43], s68 offen offset:16 sc1
    s_add_u32 s68, s68, 2048
    buffer_load_dwordx4 v[172:175], v250, s[40:43], s68 offen sc1
    buffer_load_dwordx4 v[176:179], v250, s[40:43], s68 offen offset:16 sc1
    s_add_u32 s68, s68, 2048
    buffer_load_dwordx4 v[180:183], v250, s[40:43], s68 offen sc1
    buffer_load_dwordx4 v[184:187], v250, s[40:43], s68 offen offset:16 sc1
    s_add_u32 s68, s68, 2048
    buffer_load_dwordx4 v[188:191], v250, s[40:43], s68 offen sc1
    buffer_load_dwordx4 v[192:195], v250, s[40:43], s68 offen offset:16 sc1
    s_add_u32 s68, s68, 2048
    buffer_load_dwordx4 v[196:199], v250, s[40:43], s68 offen sc1
    buffer_load_dwordx4 v[200:203], v250, s[40:43], s68 offen offset:16 sc1
    s_add_u32 s68, s68, 2048
    buffer_load_dwordx4 v[204:207], v250, s[40:43], s68 offen sc1
    buffer_load_dwordx4 v[208:211], v250, s[40:43], s68 offen offset:16 sc1
    s_add_u32 s68, s68, 2048
    buffer_load_dwordx4 v[212:215], v250, s[40:43], s68 offen sc1
    buffer_load_dwordx4 v[216:219], v250, s[40:43], s68 offen offset:16 sc1
    s_waitcnt vmcnt(0)
L_poll1_chk:
    v_xor_b32 v241, s62, v157
    v_xor_b32 v242, s63, v159
    v_or_b32 v240, v241, v242
    v_xor_b32 v241, s62, v161
    v_xor_b32 v242, s63, v163
    v_or3_b32 v240, v240, v241, v242
    v_xor_b32 v241, s62, v165
    v_xor_b32 v242, s63, v167
    v_or3_b32 v240, v240, v241, v242
    v_xor_b32 v241, s62, v169
    v_xor_b32 v242, s63, v171
    v_or3_b32 v240, v240, v241, v242
    v_xor_b32 v241, s62, v173
    v_xor_b32 v242, s63, v175
    v_or3_b32 v240, v240, v241, v242
    v_xor_b32 v241, s62, v177
    v_xor_b32 v242, s63, v179
    v_or3_b32 v240, v240, v241, v242
    v_xor_b32 v241, s62, v181
    v_xor_b32 v242, s63, v183
    v_or3_b32 v240, v240, v241, v242
    v_xor_b32 v241, s62, v185
    v_xor_b32 v242, s63, v187
    v_or3_b32 v240, v240, v241, v242
    v_xor_b32 v241, s62, v189
    v_xor_b32 v242, s63, v191
    v_or3_b32 v240, v240, v241, v242
    v_xor_b32 v241, s62, v193
    v_xor_b32 v242, s63, v195
    v_or3_b32 v240, v240, v241, v242
    v_xor_b32 v241, s62, v197
    v_xor_b32 v242, s63, v199
    v_or3_b32 v240, v240, v241, v242
    v_xor_b32 v241, s62, v201
    v_xor_b32 v242, s63, v203
    v_or3_b32 v240, v240, v241, v242
    v_xor_b32 v241, s62, v205
    v_xor_b32 v242, s63, v207
    v_or3_b32 v240, v240, v241, v242
    v_xor_b32 v241, s62, v209
    v_xor_b32 v242, s63, v211
    v_or3_b32 v240, v240, v241, v242
    v_xor_b32 v241, s62, v213
    v_xor_b32 v242, s63, v215
    v_or3_b32 v240, v240, v241, v242
    v_xor_b32 v241, s62, v217
    v_xor_b32 v242, s63, v219
    v_or3_b32 v240, v240, v241, v242
    v_cmp_eq_u32 vcc, 0, v240
    s_nop 0
    s_cmp_eq_u64 vcc, exec
    s_cbranch_scc1 L_poll1_ok
    s_sub_u32 s73, s73, 1
    s_cmp_lg_u32 s73, 0
    s_cbranch_scc1 L_poll1
L_poll1_ok:
    v_add_f32 v240, v156, v164
    v_add_f32 v240, v240, v172
    v_add_f32 v240, v240, v180
    v_add_f32 v240, v240, v188
    v_add_f32 v240, v240, v196
    v_add_f32 v240, v240, v204
    v_add_f32 v240, v240, v212
    v_add_f32 v241, v158, v166
    v_add_f32 v241, v241, v174
    v_add_f32 v241, v241, v182
    v_add_f32 v241, v241, v190
    v_add_f32 v241, v241, v198
    v_add_f32 v241, v241, v206
    v_add_f32 v241, v241, v214
    v_add_f32 v242, v160, v168
    v_add_f32 v242, v242, v176
    v_add_f32 v242, v242, v184
    v_add_f32 v242, v242, v192
    v_add_f32 v242, v242, v200
    v_add_f32 v242, v242, v208
    v_add_f32 v242, v242, v216
    v_add_f32 v243, v162, v170
    v_add_f32 v243, v243, v178
    v_add_f32 v243, v243, v186
    v_add_f32 v243, v243, v194
    v_add_f32 v243, v243, v202
    v_add_f32 v243, v243, v210
    v_add_f32 v243, v243, v218
    v_cvt_pk_bf16_f32 v240, v240, v241
    v_cvt_pk_bf16_f32 v241, v242, v243
    v_lshlrev_b32 v10, 3, v1
    ds_write_b64 v10, v[240:241] offset:5696
    v_mov_b32 v11, s61
    ds_write_b32 v3, v11 offset:5664
    s_mov_b64 exec, -1
    s_branch L_join
L_pref:
    s_mov_b32 s32, s10
    s_and_b32 s33, s11, 0xffff
    s_mov_b32 s34, 402653184
    s_mov_b32 s35, 0x20000
    s_mov_b32 s36, s12
    s_and_b32 s37, s13, 0xffff
    s_mov_b32 s38, 402653184
    s_mov_b32 s39, 0x20000
    s_mov_b32 s40, s30
    s_and_b32 s41, s31, 0xffff
    s_mov_b32 s42, 3145728
    s_mov_b32 s43, 0x20000
    v_and_b32 v11, 7, v1
    v_lshrrev_b32 v12, 4, v1
    v_and_b32 v13, 1, v12
    v_mul_u32_u24 v13, 12, v13
    v_lshrrev_b32 v12, 1, v12
    v_mad_u32_u24 v13, v12, 6, v13
    v_add_u32 v12, 0, v13
    v_lshrrev_b32 v16, 3, v12
    v_lshlrev_b32 v16, 8, v16
    v_and_b32 v12, 7, v12
    v_lshl_add_u32 v16, v12, 2, v16
    v_lshl_add_u32 v16, v11, 5, v16
    v_add_u32 v12, 1, v13
    v_lshrrev_b32 v17, 3, v12
    v_lshlrev_b32 v17, 8, v17
    v_and_b32 v12, 7, v12
    v_lshl_add_u32 v17, v12, 2, v17
    v_lshl_add_u32 v17, v11, 5, v17
    v_add_u32 v12, 2, v13
    v_lshrrev_b32 v18, 3, v12
    v_lshlrev_b32 v18, 8, v18
    v_and_b32 v12, 7, v12
    v_lshl_add_u32 v18, v12, 2, v18
    v_lshl_add_u32 v18, v11, 5, v18
    v_add_u32 v12, 3, v13
    v_lshrrev_b32 v19, 3, v12
    v_lshlrev_b32 v19, 8, v19
    v_and_b32 v12, 7, v12
    v_lshl_add_u32 v19, v12, 2, v19
    v_lshl_add_u32 v19, v11, 5, v19
    v_add_u32 v12, 4, v13
    v_lshrrev_b32 v20, 3, v12
    v_lshlrev_b32 v20, 8, v20
    v_and_b32 v12, 7, v12
    v_lshl_add_u32 v20, v12, 2, v20
    v_lshl_add_u32 v20, v11, 5, v20
    v_add_u32 v12, 5, v13
    v_lshrrev_b32 v21, 3, v12
    v_lshlrev_b32 v21, 8, v21
    v_and_b32 v12, 7, v12
    v_lshl_add_u32 v21, v12, 2, v21
    v_lshl_add_u32 v21, v11, 5, v21
    s_barrier
    buffer_load_dwordx4 v[60:63], v2, s[32:35], s58 offen offset:0 nt
    buffer_load_dwordx4 v[64:67], v2, s[32:35], s58 offen offset:128 nt
    buffer_load_dwordx4 v[68:71], v2, s[32:35], s58 offen offset:256 nt
    buffer_load_dwordx4 v[108:111], v2, s[36:39], s58 offen offset:0 nt
    buffer_load_dwordx4 v[112:115], v2, s[36:39], s58 offen offset:128 nt
    buffer_load_dwordx4 v[116:119], v2, s[36:39], s58 offen offset:256 nt
    buffer_load_dwordx4 v[72:75], v2, s[32:35], s58 offen offset:384 nt
    buffer_load_dwordx4 v[76:79], v2, s[32:35], s58 offen offset:512 nt
    buffer_load_dwordx4 v[80:83], v2, s[32:35], s58 offen offset:640 nt
    buffer_load_dwordx4 v[120:123], v2, s[36:39], s58 offen offset:384 nt
    buffer_load_dwordx4 v[124:127], v2, s[36:39], s58 offen offset:512 nt
    buffer_load_dwordx4 v[128:131], v2, s[36:39], s58 offen offset:640 nt
    s_barrier
    buffer_load_dwordx4 v[84:87], v2, s[32:35], s59 offen offset:0 nt
    buffer_load_dwordx4 v[88:91], v2, s[32:35], s59 offen offset:128 nt
    buffer_load_dwordx4 v[92:95], v2, s[32:35], s59 offen offset:256 nt
    buffer_load_dwordx4 v[132:135], v2, s[36:39], s59 offen offset:0 nt
    buffer_load_dwordx4 v[136:139], v2, s[36:39], s59 offen offset:128 nt
    buffer_load_dwordx4 v[140:143], v2, s[36:39], s59 offen offset:256 nt
    buffer_load_dwordx4 v[96:99], v2, s[32:35], s59 offen offset:384 nt
    buffer_load_dwordx4 v[100:103], v2, s[32:35], s59 offen offset:512 nt
    buffer_load_dwordx4 v[104:107], v2, s[32:35], s59 offen offset:640 nt
    buffer_load_dwordx4 v[144:147], v2, s[36:39], s59 offen offset:384 nt
    buffer_load_dwordx4 v[148:151], v2, s[36:39], s59 offen offset:512 nt
    buffer_load_dwordx4 v[152:155], v2, s[36:39], s59 offen offset:640 nt
    s_waitcnt lgkmcnt(0)
    s_add_u32 s62, s62, 0x7F4A7C15
    s_addc_u32 s63, s63, 0x9E3779B9
L_join:
    s_waitcnt lgkmcnt(0)
    s_barrier
    v_and_b32 v10, 7, v1
    v_lshlrev_b32 v10, 4, v10
    ds_read_b128 v[24:27], v10 offset:5696
    ds_read_b128 v[28:31], v10 offset:5824
    ds_read_b128 v[32:35], v10 offset:5952
    ds_read_b32 v11, v3 offset:5664
    s_waitcnt lgkmcnt(0)
    v_readfirstlane_b32 s61, v11
    s_and_b32 s67, s53, 7
    s_cmp_lg_u32 s67, s54
    s_cbranch_scc1 L_main
    s_cmp_ge_u32 s53, 24
    s_cbranch_scc1 L_main
    s_mov_b32 s44, s20
    s_and_b32 s45, s21, 0xffff
    s_mov_b32 s46, 1966080
    s_mov_b32 s47, 0x20000
    s_mov_b32 s48, s22
    s_and_b32 s49, s23, 0xffff
    s_mov_b32 s50, 1966080
    s_mov_b32 s51, 0x20000
    v_lshrrev_b32 v10, 3, v1
    v_and_b32 v11, 7, v1
    v_mul_u32_u24 v14, 3072, v10
    v_lshl_add_u32 v14, v11, 4, v14
    s_lshl_b32 s67, s52, 5
    v_lshl_add_u32 v15, v10, 2, s67
    s_mul_i32 s72, s52, 24576
    s_lshl_b32 s68, s53, 7
    s_add_u32 s72, s72, s68
    v_mov_b32 v36, 0
    v_mov_b32 v37, 0
    v_mov_b32 v38, 0
    v_mov_b32 v39, 0
    v_mov_b32 v40, 0
    v_mov_b32 v41, 0
    v_mov_b32 v42, 0
    v_mov_b32 v43, 0
    v_mov_b32 v44, 0
    v_mov_b32 v45, 0
    v_mov_b32 v46, 0
    v_mov_b32 v47, 0
    v_mov_b32 v48, 0
    v_mov_b32 v49, 0
    v_mov_b32 v50, 0
    v_mov_b32 v51, 0
    s_mov_b32 s69, 0
L_gu:
    buffer_load_dwordx4 v[156:159], v14, s[44:47], s72 offen nt
    buffer_load_dwordx4 v[160:163], v14, s[48:51], s72 offen nt
    s_add_u32 s72, s72, 98304
    buffer_load_dwordx4 v[164:167], v14, s[44:47], s72 offen nt
    buffer_load_dwordx4 v[168:171], v14, s[48:51], s72 offen nt
    s_add_u32 s72, s72, 98304
    buffer_load_dwordx4 v[172:175], v14, s[44:47], s72 offen nt
    buffer_load_dwordx4 v[176:179], v14, s[48:51], s72 offen nt
    s_add_u32 s72, s72, 98304
    buffer_load_dwordx4 v[180:183], v14, s[44:47], s72 offen nt
    buffer_load_dwordx4 v[184:187], v14, s[48:51], s72 offen nt
    s_add_u32 s72, s72, 98304
    buffer_load_dwordx4 v[188:191], v14, s[44:47], s72 offen nt
    buffer_load_dwordx4 v[192:195], v14, s[48:51], s72 offen nt
    s_add_u32 s72, s72, 98304
    buffer_load_dwordx4 v[196:199], v14, s[44:47], s72 offen nt
    buffer_load_dwordx4 v[200:203], v14, s[48:51], s72 offen nt
    s_add_u32 s72, s72, 98304
    buffer_load_dwordx4 v[204:207], v14, s[44:47], s72 offen nt
    buffer_load_dwordx4 v[208:211], v14, s[48:51], s72 offen nt
    s_add_u32 s72, s72, 98304
    buffer_load_dwordx4 v[212:215], v14, s[44:47], s72 offen nt
    buffer_load_dwordx4 v[216:219], v14, s[48:51], s72 offen nt
    s_add_u32 s72, s72, 98304
    buffer_load_dwordx4 v[220:223], v14, s[44:47], s72 offen nt
    buffer_load_dwordx4 v[224:227], v14, s[48:51], s72 offen nt
    s_add_u32 s72, s72, 98304
    buffer_load_dwordx4 v[228:231], v14, s[44:47], s72 offen nt
    buffer_load_dwordx4 v[232:235], v14, s[48:51], s72 offen nt
    s_add_u32 s72, s72, 98304
    ds_read_b32 v8, v15 offset:0
    s_waitcnt vmcnt(18) lgkmcnt(0)
    v_lshlrev_b32 v10, 16, v156
    v_and_b32 v11, s66, v156
    v_pk_fma_f32 v[36:37], v[10:11], v[8:9], v[36:37] op_sel_hi:[1,0,1]
    v_lshlrev_b32 v12, 16, v157
    v_and_b32 v13, s66, v157
    v_pk_fma_f32 v[38:39], v[12:13], v[8:9], v[38:39] op_sel_hi:[1,0,1]
    v_lshlrev_b32 v10, 16, v158
    v_and_b32 v11, s66, v158
    v_pk_fma_f32 v[40:41], v[10:11], v[8:9], v[40:41] op_sel_hi:[1,0,1]
    v_lshlrev_b32 v12, 16, v159
    v_and_b32 v13, s66, v159
    v_pk_fma_f32 v[42:43], v[12:13], v[8:9], v[42:43] op_sel_hi:[1,0,1]
    v_lshlrev_b32 v10, 16, v160
    v_and_b32 v11, s66, v160
    v_pk_fma_f32 v[44:45], v[10:11], v[8:9], v[44:45] op_sel_hi:[1,0,1]
    v_lshlrev_b32 v12, 16, v161
    v_and_b32 v13, s66, v161
    v_pk_fma_f32 v[46:47], v[12:13], v[8:9], v[46:47] op_sel_hi:[1,0,1]
    v_lshlrev_b32 v10, 16, v162
    v_and_b32 v11, s66, v162
    v_pk_fma_f32 v[48:49], v[10:11], v[8:9], v[48:49] op_sel_hi:[1,0,1]
    v_lshlrev_b32 v12, 16, v163
    v_and_b32 v13, s66, v163
    v_pk_fma_f32 v[50:51], v[12:13], v[8:9], v[50:51] op_sel_hi:[1,0,1]
    ds_read_b32 v8, v15 offset:128
    s_waitcnt vmcnt(16) lgkmcnt(0)
    v_lshlrev_b32 v10, 16, v164
    v_and_b32 v11, s66, v164
    v_pk_fma_f32 v[36:37], v[10:11], v[8:9], v[36:37] op_sel_hi:[1,0,1]
    v_lshlrev_b32 v12, 16, v165
    v_and_b32 v13, s66, v165
    v_pk_fma_f32 v[38:39], v[12:13], v[8:9], v[38:39] op_sel_hi:[1,0,1]
    v_lshlrev_b32 v10, 16, v166
    v_and_b32 v11, s66, v166
    v_pk_fma_f32 v[40:41], v[10:11], v[8:9], v[40:41] op_sel_hi:[1,0,1]
    v_lshlrev_b32 v12, 16, v167
    v_and_b32 v13, s66, v167
    v_pk_fma_f32 v[42:43], v[12:13], v[8:9], v[42:43] op_sel_hi:[1,0,1]
    v_lshlrev_b32 v10, 16, v168
    v_and_b32 v11, s66, v168
    v_pk_fma_f32 v[44:45], v[10:11], v[8:9], v[44:45] op_sel_hi:[1,0,1]
    v_lshlrev_b32 v12, 16, v169
    v_and_b32 v13, s66, v169
    v_pk_fma_f32 v[46:47], v[12:13], v[8:9], v[46:47] op_sel_hi:[1,0,1]
    v_lshlrev_b32 v10, 16, v170
    v_and_b32 v11, s66, v170
    v_pk_fma_f32 v[48:49], v[10:11], v[8:9], v[48:49] op_sel_hi:[1,0,1]
    v_lshlrev_b32 v12, 16, v171
    v_and_b32 v13, s66, v171
    v_pk_fma_f32 v[50:51], v[12:13], v[8:9], v[50:51] op_sel_hi:[1,0,1]
    ds_read_b32 v8, v15 offset:256
    s_waitcnt vmcnt(14) lgkmcnt(0)
    v_lshlrev_b32 v10, 16, v172
    v_and_b32 v11, s66, v172
    v_pk_fma_f32 v[36:37], v[10:11], v[8:9], v[36:37] op_sel_hi:[1,0,1]
    v_lshlrev_b32 v12, 16, v173
    v_and_b32 v13, s66, v173
    v_pk_fma_f32 v[38:39], v[12:13], v[8:9], v[38:39] op_sel_hi:[1,0,1]
    v_lshlrev_b32 v10, 16, v174
    v_and_b32 v11, s66, v174
    v_pk_fma_f32 v[40:41], v[10:11], v[8:9], v[40:41] op_sel_hi:[1,0,1]
    v_lshlrev_b32 v12, 16, v175
    v_and_b32 v13, s66, v175
    v_pk_fma_f32 v[42:43], v[12:13], v[8:9], v[42:43] op_sel_hi:[1,0,1]
    v_lshlrev_b32 v10, 16, v176
    v_and_b32 v11, s66, v176
    v_pk_fma_f32 v[44:45], v[10:11], v[8:9], v[44:45] op_sel_hi:[1,0,1]
    v_lshlrev_b32 v12, 16, v177
    v_and_b32 v13, s66, v177
    v_pk_fma_f32 v[46:47], v[12:13], v[8:9], v[46:47] op_sel_hi:[1,0,1]
    v_lshlrev_b32 v10, 16, v178
    v_and_b32 v11, s66, v178
    v_pk_fma_f32 v[48:49], v[10:11], v[8:9], v[48:49] op_sel_hi:[1,0,1]
    v_lshlrev_b32 v12, 16, v179
    v_and_b32 v13, s66, v179
    v_pk_fma_f32 v[50:51], v[12:13], v[8:9], v[50:51] op_sel_hi:[1,0,1]
    ds_read_b32 v8, v15 offset:384
    s_waitcnt vmcnt(12) lgkmcnt(0)
    v_lshlrev_b32 v10, 16, v180
    v_and_b32 v11, s66, v180
    v_pk_fma_f32 v[36:37], v[10:11], v[8:9], v[36:37] op_sel_hi:[1,0,1]
    v_lshlrev_b32 v12, 16, v181
    v_and_b32 v13, s66, v181
    v_pk_fma_f32 v[38:39], v[12:13], v[8:9], v[38:39] op_sel_hi:[1,0,1]
    v_lshlrev_b32 v10, 16, v182
    v_and_b32 v11, s66, v182
    v_pk_fma_f32 v[40:41], v[10:11], v[8:9], v[40:41] op_sel_hi:[1,0,1]
    v_lshlrev_b32 v12, 16, v183
    v_and_b32 v13, s66, v183
    v_pk_fma_f32 v[42:43], v[12:13], v[8:9], v[42:43] op_sel_hi:[1,0,1]
    v_lshlrev_b32 v10, 16, v184
    v_and_b32 v11, s66, v184
    v_pk_fma_f32 v[44:45], v[10:11], v[8:9], v[44:45] op_sel_hi:[1,0,1]
    v_lshlrev_b32 v12, 16, v185
    v_and_b32 v13, s66, v185
    v_pk_fma_f32 v[46:47], v[12:13], v[8:9], v[46:47] op_sel_hi:[1,0,1]
    v_lshlrev_b32 v10, 16, v186
    v_and_b32 v11, s66, v186
    v_pk_fma_f32 v[48:49], v[10:11], v[8:9], v[48:49] op_sel_hi:[1,0,1]
    v_lshlrev_b32 v12, 16, v187
    v_and_b32 v13, s66, v187
    v_pk_fma_f32 v[50:51], v[12:13], v[8:9], v[50:51] op_sel_hi:[1,0,1]
    ds_read_b32 v8, v15 offset:512
    s_waitcnt vmcnt(10) lgkmcnt(0)
    v_lshlrev_b32 v10, 16, v188
    v_and_b32 v11, s66, v188
    v_pk_fma_f32 v[36:37], v[10:11], v[8:9], v[36:37] op_sel_hi:[1,0,1]
    v_lshlrev_b32 v12, 16, v189
    v_and_b32 v13, s66, v189
    v_pk_fma_f32 v[38:39], v[12:13], v[8:9], v[38:39] op_sel_hi:[1,0,1]
    v_lshlrev_b32 v10, 16, v190
    v_and_b32 v11, s66, v190
    v_pk_fma_f32 v[40:41], v[10:11], v[8:9], v[40:41] op_sel_hi:[1,0,1]
    v_lshlrev_b32 v12, 16, v191
    v_and_b32 v13, s66, v191
    v_pk_fma_f32 v[42:43], v[12:13], v[8:9], v[42:43] op_sel_hi:[1,0,1]
    v_lshlrev_b32 v10, 16, v192
    v_and_b32 v11, s66, v192
    v_pk_fma_f32 v[44:45], v[10:11], v[8:9], v[44:45] op_sel_hi:[1,0,1]
    v_lshlrev_b32 v12, 16, v193
    v_and_b32 v13, s66, v193
    v_pk_fma_f32 v[46:47], v[12:13], v[8:9], v[46:47] op_sel_hi:[1,0,1]
    v_lshlrev_b32 v10, 16, v194
    v_and_b32 v11, s66, v194
    v_pk_fma_f32 v[48:49], v[10:11], v[8:9], v[48:49] op_sel_hi:[1,0,1]
    v_lshlrev_b32 v12, 16, v195
    v_and_b32 v13, s66, v195
    v_pk_fma_f32 v[50:51], v[12:13], v[8:9], v[50:51] op_sel_hi:[1,0,1]
    ds_read_b32 v8, v15 offset:640
    s_waitcnt vmcnt(8) lgkmcnt(0)
    v_lshlrev_b32 v10, 16, v196
    v_and_b32 v11, s66, v196
    v_pk_fma_f32 v[36:37], v[10:11], v[8:9], v[36:37] op_sel_hi:[1,0,1]
    v_lshlrev_b32 v12, 16, v197
    v_and_b32 v13, s66, v197
    v_pk_fma_f32 v[38:39], v[12:13], v[8:9], v[38:39] op_sel_hi:[1,0,1]
    v_lshlrev_b32 v10, 16, v198
    v_and_b32 v11, s66, v198
    v_pk_fma_f32 v[40:41], v[10:11], v[8:9], v[40:41] op_sel_hi:[1,0,1]
    v_lshlrev_b32 v12, 16, v199
    v_and_b32 v13, s66, v199
    v_pk_fma_f32 v[42:43], v[12:13], v[8:9], v[42:43] op_sel_hi:[1,0,1]
    v_lshlrev_b32 v10, 16, v200
    v_and_b32 v11, s66, v200
    v_pk_fma_f32 v[44:45], v[10:11], v[8:9], v[44:45] op_sel_hi:[1,0,1]
    v_lshlrev_b32 v12, 16, v201
    v_and_b32 v13, s66, v201
    v_pk_fma_f32 v[46:47], v[12:13], v[8:9], v[46:47] op_sel_hi:[1,0,1]
    v_lshlrev_b32 v10, 16, v202
    v_and_b32 v11, s66, v202
    v_pk_fma_f32 v[48:49], v[10:11], v[8:9], v[48:49] op_sel_hi:[1,0,1]
    v_lshlrev_b32 v12, 16, v203
    v_and_b32 v13, s66, v203
    v_pk_fma_f32 v[50:51], v[12:13], v[8:9], v[50:51] op_sel_hi:[1,0,1]
    ds_read_b32 v8, v15 offset:768
    s_waitcnt vmcnt(6) lgkmcnt(0)
    v_lshlrev_b32 v10, 16, v204
    v_and_b32 v11, s66, v204
    v_pk_fma_f32 v[36:37], v[10:11], v[8:9], v[36:37] op_sel_hi:[1,0,1]
    v_lshlrev_b32 v12, 16, v205
    v_and_b32 v13, s66, v205
    v_pk_fma_f32 v[38:39], v[12:13], v[8:9], v[38:39] op_sel_hi:[1,0,1]
    v_lshlrev_b32 v10, 16, v206
    v_and_b32 v11, s66, v206
    v_pk_fma_f32 v[40:41], v[10:11], v[8:9], v[40:41] op_sel_hi:[1,0,1]
    v_lshlrev_b32 v12, 16, v207
    v_and_b32 v13, s66, v207
    v_pk_fma_f32 v[42:43], v[12:13], v[8:9], v[42:43] op_sel_hi:[1,0,1]
    v_lshlrev_b32 v10, 16, v208
    v_and_b32 v11, s66, v208
    v_pk_fma_f32 v[44:45], v[10:11], v[8:9], v[44:45] op_sel_hi:[1,0,1]
    v_lshlrev_b32 v12, 16, v209
    v_and_b32 v13, s66, v209
    v_pk_fma_f32 v[46:47], v[12:13], v[8:9], v[46:47] op_sel_hi:[1,0,1]
    v_lshlrev_b32 v10, 16, v210
    v_and_b32 v11, s66, v210
    v_pk_fma_f32 v[48:49], v[10:11], v[8:9], v[48:49] op_sel_hi:[1,0,1]
    v_lshlrev_b32 v12, 16, v211
    v_and_b32 v13, s66, v211
    v_pk_fma_f32 v[50:51], v[12:13], v[8:9], v[50:51] op_sel_hi:[1,0,1]
    ds_read_b32 v8, v15 offset:896
    s_waitcnt vmcnt(4) lgkmcnt(0)
    v_lshlrev_b32 v10, 16, v212
    v_and_b32 v11, s66, v212
    v_pk_fma_f32 v[36:37], v[10:11], v[8:9], v[36:37] op_sel_hi:[1,0,1]
    v_lshlrev_b32 v12, 16, v213
    v_and_b32 v13, s66, v213
    v_pk_fma_f32 v[38:39], v[12:13], v[8:9], v[38:39] op_sel_hi:[1,0,1]
    v_lshlrev_b32 v10, 16, v214
    v_and_b32 v11, s66, v214
    v_pk_fma_f32 v[40:41], v[10:11], v[8:9], v[40:41] op_sel_hi:[1,0,1]
    v_lshlrev_b32 v12, 16, v215
    v_and_b32 v13, s66, v215
    v_pk_fma_f32 v[42:43], v[12:13], v[8:9], v[42:43] op_sel_hi:[1,0,1]
    v_lshlrev_b32 v10, 16, v216
    v_and_b32 v11, s66, v216
    v_pk_fma_f32 v[44:45], v[10:11], v[8:9], v[44:45] op_sel_hi:[1,0,1]
    v_lshlrev_b32 v12, 16, v217
    v_and_b32 v13, s66, v217
    v_pk_fma_f32 v[46:47], v[12:13], v[8:9], v[46:47] op_sel_hi:[1,0,1]
    v_lshlrev_b32 v10, 16, v218
    v_and_b32 v11, s66, v218
    v_pk_fma_f32 v[48:49], v[10:11], v[8:9], v[48:49] op_sel_hi:[1,0,1]
    v_lshlrev_b32 v12, 16, v219
    v_and_b32 v13, s66, v219
    v_pk_fma_f32 v[50:51], v[12:13], v[8:9], v[50:51] op_sel_hi:[1,0,1]
    ds_read_b32 v8, v15 offset:1024
    s_waitcnt vmcnt(2) lgkmcnt(0)
    v_lshlrev_b32 v10, 16, v220
    v_and_b32 v11, s66, v220
    v_pk_fma_f32 v[36:37], v[10:11], v[8:9], v[36:37] op_sel_hi:[1,0,1]
    v_lshlrev_b32 v12, 16, v221
    v_and_b32 v13, s66, v221
    v_pk_fma_f32 v[38:39], v[12:13], v[8:9], v[38:39] op_sel_hi:[1,0,1]
    v_lshlrev_b32 v10, 16, v222
    v_and_b32 v11, s66, v222
    v_pk_fma_f32 v[40:41], v[10:11], v[8:9], v[40:41] op_sel_hi:[1,0,1]
    v_lshlrev_b32 v12, 16, v223
    v_and_b32 v13, s66, v223
    v_pk_fma_f32 v[42:43], v[12:13], v[8:9], v[42:43] op_sel_hi:[1,0,1]
    v_lshlrev_b32 v10, 16, v224
    v_and_b32 v11, s66, v224
    v_pk_fma_f32 v[44:45], v[10:11], v[8:9], v[44:45] op_sel_hi:[1,0,1]
    v_lshlrev_b32 v12, 16, v225
    v_and_b32 v13, s66, v225
    v_pk_fma_f32 v[46:47], v[12:13], v[8:9], v[46:47] op_sel_hi:[1,0,1]
    v_lshlrev_b32 v10, 16, v226
    v_and_b32 v11, s66, v226
    v_pk_fma_f32 v[48:49], v[10:11], v[8:9], v[48:49] op_sel_hi:[1,0,1]
    v_lshlrev_b32 v12, 16, v227
    v_and_b32 v13, s66, v227
    v_pk_fma_f32 v[50:51], v[12:13], v[8:9], v[50:51] op_sel_hi:[1,0,1]
    ds_read_b32 v8, v15 offset:1152
    s_waitcnt vmcnt(0) lgkmcnt(0)
    v_lshlrev_b32 v10, 16, v228
    v_and_b32 v11, s66, v228
    v_pk_fma_f32 v[36:37], v[10:11], v[8:9], v[36:37] op_sel_hi:[1,0,1]
    v_lshlrev_b32 v12, 16, v229
    v_and_b32 v13, s66, v229
    v_pk_fma_f32 v[38:39], v[12:13], v[8:9], v[38:39] op_sel_hi:[1,0,1]
    v_lshlrev_b32 v10, 16, v230
    v_and_b32 v11, s66, v230
    v_pk_fma_f32 v[40:41], v[10:11], v[8:9], v[40:41] op_sel_hi:[1,0,1]
    v_lshlrev_b32 v12, 16, v231
    v_and_b32 v13, s66, v231
    v_pk_fma_f32 v[42:43], v[12:13], v[8:9], v[42:43] op_sel_hi:[1,0,1]
    v_lshlrev_b32 v10, 16, v232
    v_and_b32 v11, s66, v232
    v_pk_fma_f32 v[44:45], v[10:11], v[8:9], v[44:45] op_sel_hi:[1,0,1]
    v_lshlrev_b32 v12, 16, v233
    v_and_b32 v13, s66, v233
    v_pk_fma_f32 v[46:47], v[12:13], v[8:9], v[46:47] op_sel_hi:[1,0,1]
    v_lshlrev_b32 v10, 16, v234
    v_and_b32 v11, s66, v234
    v_pk_fma_f32 v[48:49], v[10:11], v[8:9], v[48:49] op_sel_hi:[1,0,1]
    v_lshlrev_b32 v12, 16, v235
    v_and_b32 v13, s66, v235
    v_pk_fma_f32 v[50:51], v[12:13], v[8:9], v[50:51] op_sel_hi:[1,0,1]
    v_add_u32 v15, 1280, v15
    s_add_u32 s69, s69, 1
    s_cmp_lt_u32 s69, 2
    s_cbranch_scc1 L_gu
    s_mov_b32 s44, s24
    s_and_b32 s45, s25, 0xffff
    s_mov_b32 s46, 1966080
    s_mov_b32 s47, 0x20000
    v_lshrrev_b32 v10, 3, v1
    v_and_b32 v11, 7, v1
    v_mul_u32_u24 v14, 1280, v10
    v_lshl_add_u32 v14, v11, 4, v14
    s_cmp_ge_u32 s52, 2
    s_cselect_b32 s67, 1073741824, 0
    v_add_u32 v5, s67, v14
    s_mul_i32 s67, s53, 81920
    s_lshl_b32 s68, s52, 7
    s_add_u32 s67, s67, s68
    buffer_load_dwordx4 v[156:159], v14, s[44:47], s67 offen offset:0 nt
    buffer_load_dwordx4 v[160:163], v14, s[44:47], s67 offen offset:512 nt
    buffer_load_dwordx4 v[164:167], v5, s[44:47], s67 offen offset:1024 nt
    s_add_u32 s67, s67, 10240
    buffer_load_dwordx4 v[168:171], v14, s[44:47], s67 offen offset:0 nt
    buffer_load_dwordx4 v[172:175], v14, s[44:47], s67 offen offset:512 nt
    buffer_load_dwordx4 v[176:179], v5, s[44:47], s67 offen offset:1024 nt
    s_add_u32 s67, s67, 10240
    buffer_load_dwordx4 v[180:183], v14, s[44:47], s67 offen offset:0 nt
    buffer_load_dwordx4 v[184:187], v14, s[44:47], s67 offen offset:512 nt
    buffer_load_dwordx4 v[188:191], v5, s[44:47], s67 offen offset:1024 nt
    s_add_u32 s67, s67, 10240
    buffer_load_dwordx4 v[192:195], v14, s[44:47], s67 offen offset:0 nt
    buffer_load_dwordx4 v[196:199], v14, s[44:47], s67 offen offset:512 nt
    buffer_load_dwordx4 v[200:203], v5, s[44:47], s67 offen offset:1024 nt
    s_add_u32 s67, s67, 10240
    buffer_load_dwordx4 v[204:207], v14, s[44:47], s67 offen offset:0 nt
    buffer_load_dwordx4 v[208:211], v14, s[44:47], s67 offen offset:512 nt
    buffer_load_dwordx4 v[212:215], v5, s[44:47], s67 offen offset:1024 nt
    s_add_u32 s67, s67, 10240
    buffer_load_dwordx4 v[216:219], v14, s[44:47], s67 offen offset:0 nt
    buffer_load_dwordx4 v[220:223], v14, s[44:47], s67 offen offset:512 nt
    buffer_load_dwordx4 v[224:227], v5, s[44:47], s67 offen offset:1024 nt
    s_add_u32 s67, s67, 10240
    buffer_load_dwordx4 v[228:231], v14, s[44:47], s67 offen offset:0 nt
    buffer_load_dwordx4 v[232:235], v14, s[44:47], s67 offen offset:512 nt
    buffer_load_dwordx4 v[236:239], v5, s[44:47], s67 offen offset:1024 nt
    s_add_u32 s67, s67, 10240
    buffer_load_dwordx4 v[240:243], v14, s[44:47], s67 offen offset:0 nt
    buffer_load_dwordx4 v[244:247], v14, s[44:47], s67 offen offset:512 nt
    buffer_load_dwordx4 v[248:251], v5, s[44:47], s67 offen offset:1024 nt
    v_add_f32_dpp v36, v36, v36 row_ror:8 row_mask:0xf bank_mask:0xf
    v_add_f32_dpp v37, v37, v37 row_ror:8 row_mask:0xf bank_mask:0xf
    v_add_f32_dpp v38, v38, v38 row_ror:8 row_mask:0xf bank_mask:0xf
    v_add_f32_dpp v39, v39, v39 row_ror:8 row_mask:0xf bank_mask:0xf
    v_add_f32_dpp v40, v40, v40 row_ror:8 row_mask:0xf bank_mask:0xf
    v_add_f32_dpp v41, v41, v41 row_ror:8 row_mask:0xf bank_mask:0xf
    v_add_f32_dpp v42, v42, v42 row_ror:8 row_mask:0xf bank_mask:0xf
    v_add_f32_dpp v43, v43, v43 row_ror:8 row_mask:0xf bank_mask:0xf
    v_add_f32_dpp v44, v44, v44 row_ror:8 row_mask:0xf bank_mask:0xf
    v_add_f32_dpp v45, v45, v45 row_ror:8 row_mask:0xf bank_mask:0xf
    v_add_f32_dpp v46, v46, v46 row_ror:8 row_mask:0xf bank_mask:0xf
    v_add_f32_dpp v47, v47, v47 row_ror:8 row_mask:0xf bank_mask:0xf
    v_add_f32_dpp v48, v48, v48 row_ror:8 row_mask:0xf bank_mask:0xf
    v_add_f32_dpp v49, v49, v49 row_ror:8 row_mask:0xf bank_mask:0xf
    v_add_f32_dpp v50, v50, v50 row_ror:8 row_mask:0xf bank_mask:0xf
    v_add_f32_dpp v51, v51, v51 row_ror:8 row_mask:0xf bank_mask:0xf
    v_permlane16_swap_b32 v36, v44
    v_permlane16_swap_b32 v37, v45
    v_permlane16_swap_b32 v38, v46
    v_permlane16_swap_b32 v39, v47
    v_permlane16_swap_b32 v40, v48
    v_permlane16_swap_b32 v41, v49
    v_permlane16_swap_b32 v42, v50
    v_permlane16_swap_b32 v43, v51
    v_add_f32 v36, v36, v44
    v_add_f32 v37, v37, v45
    v_add_f32 v38, v38, v46
    v_add_f32 v39, v39, v47
    v_add_f32 v40, v40, v48
    v_add_f32 v41, v41, v49
    v_add_f32 v42, v42, v50
    v_add_f32 v43, v43, v51
    v_permlane32_swap_b32 v36, v40
    v_permlane32_swap_b32 v37, v41
    v_permlane32_swap_b32 v38, v42
    v_permlane32_swap_b32 v39, v43
    v_add_f32 v36, v36, v40
    v_add_f32 v37, v37, v41
    v_add_f32 v38, v38, v42
    v_add_f32 v39, v39, v43
    v_lshrrev_b32 v10, 4, v1
    v_and_b32 v11, 1, v10
    v_lshlrev_b32 v11, 8, v11
    v_lshrrev_b32 v10, 1, v10
    v_lshl_add_u32 v11, v10, 4, v11
    v_and_b32 v10, 7, v1
    v_lshl_add_u32 v11, v10, 5, v11
    s_lshl_b32 s67, s52, 9
    v_add_u32 v11, s67, v11
    ds_write_b128 v11, v[36:39] offset:6720
    s_waitcnt lgkmcnt(0)
    s_barrier
    s_cmp_lg_u32 s52, 0
    s_cbranch_scc1 L_ffn_h
    v_lshlrev_b32 v10, 2, v0
    ds_read_b32 v36, v10 offset:6720
    ds_read_b32 v40, v10 offset:6976
    ds_read_b32 v37, v10 offset:7232
    ds_read_b32 v41, v10 offset:7488
    ds_read_b32 v38, v10 offset:7744
    ds_read_b32 v42, v10 offset:8000
    ds_read_b32 v39, v10 offset:8256
    ds_read_b32 v43, v10 offset:8512
    s_waitcnt lgkmcnt(0)
    v_add_f32 v36, v36, v37
    v_add_f32 v36, v36, v38
    v_add_f32 v36, v36, v39
    v_cvt_pk_bf16_f32 v36, v36, v36
    v_and_b32 v36, s66, v36
    v_add_f32 v40, v40, v41
    v_add_f32 v40, v40, v42
    v_add_f32 v40, v40, v43
    v_cvt_pk_bf16_f32 v40, v40, v40
    v_and_b32 v40, s66, v40
    v_max_f32 v36, 0, v36
    v_mul_f32 v36, v36, v40
    v_cvt_pk_bf16_f32 v36, v36, v36
    v_and_b32 v36, s66, v36
    ds_write_b32 v10, v36 offset:6080
L_ffn_h:
    s_waitcnt lgkmcnt(0)
    s_barrier
    v_mov_b32 v36, 0
    v_mov_b32 v37, 0
    v_mov_b32 v38, 0
    v_mov_b32 v39, 0
    v_mov_b32 v40, 0
    v_mov_b32 v41, 0
    v_mov_b32 v42, 0
    v_mov_b32 v43, 0
    v_mov_b32 v44, 0
    v_mov_b32 v45, 0
    v_mov_b32 v46, 0
    v_mov_b32 v47, 0
    v_mov_b32 v48, 0
    v_mov_b32 v49, 0
    v_mov_b32 v50, 0
    v_mov_b32 v51, 0
    v_mov_b32 v52, 0
    v_mov_b32 v53, 0
    v_mov_b32 v54, 0
    v_mov_b32 v55, 0
    v_mov_b32 v56, 0
    v_mov_b32 v57, 0
    v_mov_b32 v58, 0
    v_mov_b32 v59, 0
    v_lshrrev_b32 v10, 3, v1
    v_lshlrev_b32 v15, 2, v10
    s_waitcnt vmcnt(0)
    ds_read_b32 v8, v15 offset:6080
    s_waitcnt lgkmcnt(0)
    v_lshlrev_b32 v10, 16, v156
    v_and_b32 v11, s66, v156
    v_pk_fma_f32 v[36:37], v[10:11], v[8:9], v[36:37] op_sel_hi:[1,0,1]
    v_lshlrev_b32 v12, 16, v157
    v_and_b32 v13, s66, v157
    v_pk_fma_f32 v[38:39], v[12:13], v[8:9], v[38:39] op_sel_hi:[1,0,1]
    v_lshlrev_b32 v10, 16, v158
    v_and_b32 v11, s66, v158
    v_pk_fma_f32 v[40:41], v[10:11], v[8:9], v[40:41] op_sel_hi:[1,0,1]
    v_lshlrev_b32 v12, 16, v159
    v_and_b32 v13, s66, v159
    v_pk_fma_f32 v[42:43], v[12:13], v[8:9], v[42:43] op_sel_hi:[1,0,1]
    v_lshlrev_b32 v10, 16, v160
    v_and_b32 v11, s66, v160
    v_pk_fma_f32 v[44:45], v[10:11], v[8:9], v[44:45] op_sel_hi:[1,0,1]
    v_lshlrev_b32 v12, 16, v161
    v_and_b32 v13, s66, v161
    v_pk_fma_f32 v[46:47], v[12:13], v[8:9], v[46:47] op_sel_hi:[1,0,1]
    v_lshlrev_b32 v10, 16, v162
    v_and_b32 v11, s66, v162
    v_pk_fma_f32 v[48:49], v[10:11], v[8:9], v[48:49] op_sel_hi:[1,0,1]
    v_lshlrev_b32 v12, 16, v163
    v_and_b32 v13, s66, v163
    v_pk_fma_f32 v[50:51], v[12:13], v[8:9], v[50:51] op_sel_hi:[1,0,1]
    v_lshlrev_b32 v10, 16, v164
    v_and_b32 v11, s66, v164
    v_pk_fma_f32 v[52:53], v[10:11], v[8:9], v[52:53] op_sel_hi:[1,0,1]
    v_lshlrev_b32 v12, 16, v165
    v_and_b32 v13, s66, v165
    v_pk_fma_f32 v[54:55], v[12:13], v[8:9], v[54:55] op_sel_hi:[1,0,1]
    v_lshlrev_b32 v10, 16, v166
    v_and_b32 v11, s66, v166
    v_pk_fma_f32 v[56:57], v[10:11], v[8:9], v[56:57] op_sel_hi:[1,0,1]
    v_lshlrev_b32 v12, 16, v167
    v_and_b32 v13, s66, v167
    v_pk_fma_f32 v[58:59], v[12:13], v[8:9], v[58:59] op_sel_hi:[1,0,1]
    ds_read_b32 v8, v15 offset:6112
    s_waitcnt lgkmcnt(0)
    v_lshlrev_b32 v10, 16, v168
    v_and_b32 v11, s66, v168
    v_pk_fma_f32 v[36:37], v[10:11], v[8:9], v[36:37] op_sel_hi:[1,0,1]
    v_lshlrev_b32 v12, 16, v169
    v_and_b32 v13, s66, v169
    v_pk_fma_f32 v[38:39], v[12:13], v[8:9], v[38:39] op_sel_hi:[1,0,1]
    v_lshlrev_b32 v10, 16, v170
    v_and_b32 v11, s66, v170
    v_pk_fma_f32 v[40:41], v[10:11], v[8:9], v[40:41] op_sel_hi:[1,0,1]
    v_lshlrev_b32 v12, 16, v171
    v_and_b32 v13, s66, v171
    v_pk_fma_f32 v[42:43], v[12:13], v[8:9], v[42:43] op_sel_hi:[1,0,1]
    v_lshlrev_b32 v10, 16, v172
    v_and_b32 v11, s66, v172
    v_pk_fma_f32 v[44:45], v[10:11], v[8:9], v[44:45] op_sel_hi:[1,0,1]
    v_lshlrev_b32 v12, 16, v173
    v_and_b32 v13, s66, v173
    v_pk_fma_f32 v[46:47], v[12:13], v[8:9], v[46:47] op_sel_hi:[1,0,1]
    v_lshlrev_b32 v10, 16, v174
    v_and_b32 v11, s66, v174
    v_pk_fma_f32 v[48:49], v[10:11], v[8:9], v[48:49] op_sel_hi:[1,0,1]
    v_lshlrev_b32 v12, 16, v175
    v_and_b32 v13, s66, v175
    v_pk_fma_f32 v[50:51], v[12:13], v[8:9], v[50:51] op_sel_hi:[1,0,1]
    v_lshlrev_b32 v10, 16, v176
    v_and_b32 v11, s66, v176
    v_pk_fma_f32 v[52:53], v[10:11], v[8:9], v[52:53] op_sel_hi:[1,0,1]
    v_lshlrev_b32 v12, 16, v177
    v_and_b32 v13, s66, v177
    v_pk_fma_f32 v[54:55], v[12:13], v[8:9], v[54:55] op_sel_hi:[1,0,1]
    v_lshlrev_b32 v10, 16, v178
    v_and_b32 v11, s66, v178
    v_pk_fma_f32 v[56:57], v[10:11], v[8:9], v[56:57] op_sel_hi:[1,0,1]
    v_lshlrev_b32 v12, 16, v179
    v_and_b32 v13, s66, v179
    v_pk_fma_f32 v[58:59], v[12:13], v[8:9], v[58:59] op_sel_hi:[1,0,1]
    ds_read_b32 v8, v15 offset:6144
    s_waitcnt lgkmcnt(0)
    v_lshlrev_b32 v10, 16, v180
    v_and_b32 v11, s66, v180
    v_pk_fma_f32 v[36:37], v[10:11], v[8:9], v[36:37] op_sel_hi:[1,0,1]
    v_lshlrev_b32 v12, 16, v181
    v_and_b32 v13, s66, v181
    v_pk_fma_f32 v[38:39], v[12:13], v[8:9], v[38:39] op_sel_hi:[1,0,1]
    v_lshlrev_b32 v10, 16, v182
    v_and_b32 v11, s66, v182
    v_pk_fma_f32 v[40:41], v[10:11], v[8:9], v[40:41] op_sel_hi:[1,0,1]
    v_lshlrev_b32 v12, 16, v183
    v_and_b32 v13, s66, v183
    v_pk_fma_f32 v[42:43], v[12:13], v[8:9], v[42:43] op_sel_hi:[1,0,1]
    v_lshlrev_b32 v10, 16, v184
    v_and_b32 v11, s66, v184
    v_pk_fma_f32 v[44:45], v[10:11], v[8:9], v[44:45] op_sel_hi:[1,0,1]
    v_lshlrev_b32 v12, 16, v185
    v_and_b32 v13, s66, v185
    v_pk_fma_f32 v[46:47], v[12:13], v[8:9], v[46:47] op_sel_hi:[1,0,1]
    v_lshlrev_b32 v10, 16, v186
    v_and_b32 v11, s66, v186
    v_pk_fma_f32 v[48:49], v[10:11], v[8:9], v[48:49] op_sel_hi:[1,0,1]
    v_lshlrev_b32 v12, 16, v187
    v_and_b32 v13, s66, v187
    v_pk_fma_f32 v[50:51], v[12:13], v[8:9], v[50:51] op_sel_hi:[1,0,1]
    v_lshlrev_b32 v10, 16, v188
    v_and_b32 v11, s66, v188
    v_pk_fma_f32 v[52:53], v[10:11], v[8:9], v[52:53] op_sel_hi:[1,0,1]
    v_lshlrev_b32 v12, 16, v189
    v_and_b32 v13, s66, v189
    v_pk_fma_f32 v[54:55], v[12:13], v[8:9], v[54:55] op_sel_hi:[1,0,1]
    v_lshlrev_b32 v10, 16, v190
    v_and_b32 v11, s66, v190
    v_pk_fma_f32 v[56:57], v[10:11], v[8:9], v[56:57] op_sel_hi:[1,0,1]
    v_lshlrev_b32 v12, 16, v191
    v_and_b32 v13, s66, v191
    v_pk_fma_f32 v[58:59], v[12:13], v[8:9], v[58:59] op_sel_hi:[1,0,1]
    ds_read_b32 v8, v15 offset:6176
    s_waitcnt lgkmcnt(0)
    v_lshlrev_b32 v10, 16, v192
    v_and_b32 v11, s66, v192
    v_pk_fma_f32 v[36:37], v[10:11], v[8:9], v[36:37] op_sel_hi:[1,0,1]
    v_lshlrev_b32 v12, 16, v193
    v_and_b32 v13, s66, v193
    v_pk_fma_f32 v[38:39], v[12:13], v[8:9], v[38:39] op_sel_hi:[1,0,1]
    v_lshlrev_b32 v10, 16, v194
    v_and_b32 v11, s66, v194
    v_pk_fma_f32 v[40:41], v[10:11], v[8:9], v[40:41] op_sel_hi:[1,0,1]
    v_lshlrev_b32 v12, 16, v195
    v_and_b32 v13, s66, v195
    v_pk_fma_f32 v[42:43], v[12:13], v[8:9], v[42:43] op_sel_hi:[1,0,1]
    v_lshlrev_b32 v10, 16, v196
    v_and_b32 v11, s66, v196
    v_pk_fma_f32 v[44:45], v[10:11], v[8:9], v[44:45] op_sel_hi:[1,0,1]
    v_lshlrev_b32 v12, 16, v197
    v_and_b32 v13, s66, v197
    v_pk_fma_f32 v[46:47], v[12:13], v[8:9], v[46:47] op_sel_hi:[1,0,1]
    v_lshlrev_b32 v10, 16, v198
    v_and_b32 v11, s66, v198
    v_pk_fma_f32 v[48:49], v[10:11], v[8:9], v[48:49] op_sel_hi:[1,0,1]
    v_lshlrev_b32 v12, 16, v199
    v_and_b32 v13, s66, v199
    v_pk_fma_f32 v[50:51], v[12:13], v[8:9], v[50:51] op_sel_hi:[1,0,1]
    v_lshlrev_b32 v10, 16, v200
    v_and_b32 v11, s66, v200
    v_pk_fma_f32 v[52:53], v[10:11], v[8:9], v[52:53] op_sel_hi:[1,0,1]
    v_lshlrev_b32 v12, 16, v201
    v_and_b32 v13, s66, v201
    v_pk_fma_f32 v[54:55], v[12:13], v[8:9], v[54:55] op_sel_hi:[1,0,1]
    v_lshlrev_b32 v10, 16, v202
    v_and_b32 v11, s66, v202
    v_pk_fma_f32 v[56:57], v[10:11], v[8:9], v[56:57] op_sel_hi:[1,0,1]
    v_lshlrev_b32 v12, 16, v203
    v_and_b32 v13, s66, v203
    v_pk_fma_f32 v[58:59], v[12:13], v[8:9], v[58:59] op_sel_hi:[1,0,1]
    ds_read_b32 v8, v15 offset:6208
    s_waitcnt lgkmcnt(0)
    v_lshlrev_b32 v10, 16, v204
    v_and_b32 v11, s66, v204
    v_pk_fma_f32 v[36:37], v[10:11], v[8:9], v[36:37] op_sel_hi:[1,0,1]
    v_lshlrev_b32 v12, 16, v205
    v_and_b32 v13, s66, v205
    v_pk_fma_f32 v[38:39], v[12:13], v[8:9], v[38:39] op_sel_hi:[1,0,1]
    v_lshlrev_b32 v10, 16, v206
    v_and_b32 v11, s66, v206
    v_pk_fma_f32 v[40:41], v[10:11], v[8:9], v[40:41] op_sel_hi:[1,0,1]
    v_lshlrev_b32 v12, 16, v207
    v_and_b32 v13, s66, v207
    v_pk_fma_f32 v[42:43], v[12:13], v[8:9], v[42:43] op_sel_hi:[1,0,1]
    v_lshlrev_b32 v10, 16, v208
    v_and_b32 v11, s66, v208
    v_pk_fma_f32 v[44:45], v[10:11], v[8:9], v[44:45] op_sel_hi:[1,0,1]
    v_lshlrev_b32 v12, 16, v209
    v_and_b32 v13, s66, v209
    v_pk_fma_f32 v[46:47], v[12:13], v[8:9], v[46:47] op_sel_hi:[1,0,1]
    v_lshlrev_b32 v10, 16, v210
    v_and_b32 v11, s66, v210
    v_pk_fma_f32 v[48:49], v[10:11], v[8:9], v[48:49] op_sel_hi:[1,0,1]
    v_lshlrev_b32 v12, 16, v211
    v_and_b32 v13, s66, v211
    v_pk_fma_f32 v[50:51], v[12:13], v[8:9], v[50:51] op_sel_hi:[1,0,1]
    v_lshlrev_b32 v10, 16, v212
    v_and_b32 v11, s66, v212
    v_pk_fma_f32 v[52:53], v[10:11], v[8:9], v[52:53] op_sel_hi:[1,0,1]
    v_lshlrev_b32 v12, 16, v213
    v_and_b32 v13, s66, v213
    v_pk_fma_f32 v[54:55], v[12:13], v[8:9], v[54:55] op_sel_hi:[1,0,1]
    v_lshlrev_b32 v10, 16, v214
    v_and_b32 v11, s66, v214
    v_pk_fma_f32 v[56:57], v[10:11], v[8:9], v[56:57] op_sel_hi:[1,0,1]
    v_lshlrev_b32 v12, 16, v215
    v_and_b32 v13, s66, v215
    v_pk_fma_f32 v[58:59], v[12:13], v[8:9], v[58:59] op_sel_hi:[1,0,1]
    ds_read_b32 v8, v15 offset:6240
    s_waitcnt lgkmcnt(0)
    v_lshlrev_b32 v10, 16, v216
    v_and_b32 v11, s66, v216
    v_pk_fma_f32 v[36:37], v[10:11], v[8:9], v[36:37] op_sel_hi:[1,0,1]
    v_lshlrev_b32 v12, 16, v217
    v_and_b32 v13, s66, v217
    v_pk_fma_f32 v[38:39], v[12:13], v[8:9], v[38:39] op_sel_hi:[1,0,1]
    v_lshlrev_b32 v10, 16, v218
    v_and_b32 v11, s66, v218
    v_pk_fma_f32 v[40:41], v[10:11], v[8:9], v[40:41] op_sel_hi:[1,0,1]
    v_lshlrev_b32 v12, 16, v219
    v_and_b32 v13, s66, v219
    v_pk_fma_f32 v[42:43], v[12:13], v[8:9], v[42:43] op_sel_hi:[1,0,1]
    v_lshlrev_b32 v10, 16, v220
    v_and_b32 v11, s66, v220
    v_pk_fma_f32 v[44:45], v[10:11], v[8:9], v[44:45] op_sel_hi:[1,0,1]
    v_lshlrev_b32 v12, 16, v221
    v_and_b32 v13, s66, v221
    v_pk_fma_f32 v[46:47], v[12:13], v[8:9], v[46:47] op_sel_hi:[1,0,1]
    v_lshlrev_b32 v10, 16, v222
    v_and_b32 v11, s66, v222
    v_pk_fma_f32 v[48:49], v[10:11], v[8:9], v[48:49] op_sel_hi:[1,0,1]
    v_lshlrev_b32 v12, 16, v223
    v_and_b32 v13, s66, v223
    v_pk_fma_f32 v[50:51], v[12:13], v[8:9], v[50:51] op_sel_hi:[1,0,1]
    v_lshlrev_b32 v10, 16, v224
    v_and_b32 v11, s66, v224
    v_pk_fma_f32 v[52:53], v[10:11], v[8:9], v[52:53] op_sel_hi:[1,0,1]
    v_lshlrev_b32 v12, 16, v225
    v_and_b32 v13, s66, v225
    v_pk_fma_f32 v[54:55], v[12:13], v[8:9], v[54:55] op_sel_hi:[1,0,1]
    v_lshlrev_b32 v10, 16, v226
    v_and_b32 v11, s66, v226
    v_pk_fma_f32 v[56:57], v[10:11], v[8:9], v[56:57] op_sel_hi:[1,0,1]
    v_lshlrev_b32 v12, 16, v227
    v_and_b32 v13, s66, v227
    v_pk_fma_f32 v[58:59], v[12:13], v[8:9], v[58:59] op_sel_hi:[1,0,1]
    ds_read_b32 v8, v15 offset:6272
    s_waitcnt lgkmcnt(0)
    v_lshlrev_b32 v10, 16, v228
    v_and_b32 v11, s66, v228
    v_pk_fma_f32 v[36:37], v[10:11], v[8:9], v[36:37] op_sel_hi:[1,0,1]
    v_lshlrev_b32 v12, 16, v229
    v_and_b32 v13, s66, v229
    v_pk_fma_f32 v[38:39], v[12:13], v[8:9], v[38:39] op_sel_hi:[1,0,1]
    v_lshlrev_b32 v10, 16, v230
    v_and_b32 v11, s66, v230
    v_pk_fma_f32 v[40:41], v[10:11], v[8:9], v[40:41] op_sel_hi:[1,0,1]
    v_lshlrev_b32 v12, 16, v231
    v_and_b32 v13, s66, v231
    v_pk_fma_f32 v[42:43], v[12:13], v[8:9], v[42:43] op_sel_hi:[1,0,1]
    v_lshlrev_b32 v10, 16, v232
    v_and_b32 v11, s66, v232
    v_pk_fma_f32 v[44:45], v[10:11], v[8:9], v[44:45] op_sel_hi:[1,0,1]
    v_lshlrev_b32 v12, 16, v233
    v_and_b32 v13, s66, v233
    v_pk_fma_f32 v[46:47], v[12:13], v[8:9], v[46:47] op_sel_hi:[1,0,1]
    v_lshlrev_b32 v10, 16, v234
    v_and_b32 v11, s66, v234
    v_pk_fma_f32 v[48:49], v[10:11], v[8:9], v[48:49] op_sel_hi:[1,0,1]
    v_lshlrev_b32 v12, 16, v235
    v_and_b32 v13, s66, v235
    v_pk_fma_f32 v[50:51], v[12:13], v[8:9], v[50:51] op_sel_hi:[1,0,1]
    v_lshlrev_b32 v10, 16, v236
    v_and_b32 v11, s66, v236
    v_pk_fma_f32 v[52:53], v[10:11], v[8:9], v[52:53] op_sel_hi:[1,0,1]
    v_lshlrev_b32 v12, 16, v237
    v_and_b32 v13, s66, v237
    v_pk_fma_f32 v[54:55], v[12:13], v[8:9], v[54:55] op_sel_hi:[1,0,1]
    v_lshlrev_b32 v10, 16, v238
    v_and_b32 v11, s66, v238
    v_pk_fma_f32 v[56:57], v[10:11], v[8:9], v[56:57] op_sel_hi:[1,0,1]
    v_lshlrev_b32 v12, 16, v239
    v_and_b32 v13, s66, v239
    v_pk_fma_f32 v[58:59], v[12:13], v[8:9], v[58:59] op_sel_hi:[1,0,1]
    ds_read_b32 v8, v15 offset:6304
    s_waitcnt lgkmcnt(0)
    v_lshlrev_b32 v10, 16, v240
    v_and_b32 v11, s66, v240
    v_pk_fma_f32 v[36:37], v[10:11], v[8:9], v[36:37] op_sel_hi:[1,0,1]
    v_lshlrev_b32 v12, 16, v241
    v_and_b32 v13, s66, v241
    v_pk_fma_f32 v[38:39], v[12:13], v[8:9], v[38:39] op_sel_hi:[1,0,1]
    v_lshlrev_b32 v10, 16, v242
    v_and_b32 v11, s66, v242
    v_pk_fma_f32 v[40:41], v[10:11], v[8:9], v[40:41] op_sel_hi:[1,0,1]
    v_lshlrev_b32 v12, 16, v243
    v_and_b32 v13, s66, v243
    v_pk_fma_f32 v[42:43], v[12:13], v[8:9], v[42:43] op_sel_hi:[1,0,1]
    v_lshlrev_b32 v10, 16, v244
    v_and_b32 v11, s66, v244
    v_pk_fma_f32 v[44:45], v[10:11], v[8:9], v[44:45] op_sel_hi:[1,0,1]
    v_lshlrev_b32 v12, 16, v245
    v_and_b32 v13, s66, v245
    v_pk_fma_f32 v[46:47], v[12:13], v[8:9], v[46:47] op_sel_hi:[1,0,1]
    v_lshlrev_b32 v10, 16, v246
    v_and_b32 v11, s66, v246
    v_pk_fma_f32 v[48:49], v[10:11], v[8:9], v[48:49] op_sel_hi:[1,0,1]
    v_lshlrev_b32 v12, 16, v247
    v_and_b32 v13, s66, v247
    v_pk_fma_f32 v[50:51], v[12:13], v[8:9], v[50:51] op_sel_hi:[1,0,1]
    v_lshlrev_b32 v10, 16, v248
    v_and_b32 v11, s66, v248
    v_pk_fma_f32 v[52:53], v[10:11], v[8:9], v[52:53] op_sel_hi:[1,0,1]
    v_lshlrev_b32 v12, 16, v249
    v_and_b32 v13, s66, v249
    v_pk_fma_f32 v[54:55], v[12:13], v[8:9], v[54:55] op_sel_hi:[1,0,1]
    v_lshlrev_b32 v10, 16, v250
    v_and_b32 v11, s66, v250
    v_pk_fma_f32 v[56:57], v[10:11], v[8:9], v[56:57] op_sel_hi:[1,0,1]
    v_lshlrev_b32 v12, 16, v251
    v_and_b32 v13, s66, v251
    v_pk_fma_f32 v[58:59], v[12:13], v[8:9], v[58:59] op_sel_hi:[1,0,1]
    v_add_f32_dpp v36, v36, v36 row_ror:8 row_mask:0xf bank_mask:0xf
    v_add_f32_dpp v37, v37, v37 row_ror:8 row_mask:0xf bank_mask:0xf
    v_add_f32_dpp v38, v38, v38 row_ror:8 row_mask:0xf bank_mask:0xf
    v_add_f32_dpp v39, v39, v39 row_ror:8 row_mask:0xf bank_mask:0xf
    v_add_f32_dpp v40, v40, v40 row_ror:8 row_mask:0xf bank_mask:0xf
    v_add_f32_dpp v41, v41, v41 row_ror:8 row_mask:0xf bank_mask:0xf
    v_add_f32_dpp v42, v42, v42 row_ror:8 row_mask:0xf bank_mask:0xf
    v_add_f32_dpp v43, v43, v43 row_ror:8 row_mask:0xf bank_mask:0xf
    v_add_f32_dpp v44, v44, v44 row_ror:8 row_mask:0xf bank_mask:0xf
    v_add_f32_dpp v45, v45, v45 row_ror:8 row_mask:0xf bank_mask:0xf
    v_add_f32_dpp v46, v46, v46 row_ror:8 row_mask:0xf bank_mask:0xf
    v_add_f32_dpp v47, v47, v47 row_ror:8 row_mask:0xf bank_mask:0xf
    v_add_f32_dpp v48, v48, v48 row_ror:8 row_mask:0xf bank_mask:0xf
    v_add_f32_dpp v49, v49, v49 row_ror:8 row_mask:0xf bank_mask:0xf
    v_add_f32_dpp v50, v50, v50 row_ror:8 row_mask:0xf bank_mask:0xf
    v_add_f32_dpp v51, v51, v51 row_ror:8 row_mask:0xf bank_mask:0xf
    v_add_f32_dpp v52, v52, v52 row_ror:8 row_mask:0xf bank_mask:0xf
    v_add_f32_dpp v53, v53, v53 row_ror:8 row_mask:0xf bank_mask:0xf
    v_add_f32_dpp v54, v54, v54 row_ror:8 row_mask:0xf bank_mask:0xf
    v_add_f32_dpp v55, v55, v55 row_ror:8 row_mask:0xf bank_mask:0xf
    v_add_f32_dpp v56, v56, v56 row_ror:8 row_mask:0xf bank_mask:0xf
    v_add_f32_dpp v57, v57, v57 row_ror:8 row_mask:0xf bank_mask:0xf
    v_add_f32_dpp v58, v58, v58 row_ror:8 row_mask:0xf bank_mask:0xf
    v_add_f32_dpp v59, v59, v59 row_ror:8 row_mask:0xf bank_mask:0xf
    v_permlane16_swap_b32 v36, v48
    v_permlane16_swap_b32 v37, v49
    v_permlane16_swap_b32 v38, v50
    v_permlane16_swap_b32 v39, v51
    v_permlane16_swap_b32 v40, v52
    v_permlane16_swap_b32 v41, v53
    v_permlane16_swap_b32 v42, v54
    v_permlane16_swap_b32 v43, v55
    v_permlane16_swap_b32 v44, v56
    v_permlane16_swap_b32 v45, v57
    v_permlane16_swap_b32 v46, v58
    v_permlane16_swap_b32 v47, v59
    v_add_f32 v36, v36, v48
    v_add_f32 v37, v37, v49
    v_add_f32 v38, v38, v50
    v_add_f32 v39, v39, v51
    v_add_f32 v40, v40, v52
    v_add_f32 v41, v41, v53
    v_add_f32 v42, v42, v54
    v_add_f32 v43, v43, v55
    v_add_f32 v44, v44, v56
    v_add_f32 v45, v45, v57
    v_add_f32 v46, v46, v58
    v_add_f32 v47, v47, v59
    v_permlane32_swap_b32 v36, v42
    v_permlane32_swap_b32 v37, v43
    v_permlane32_swap_b32 v38, v44
    v_permlane32_swap_b32 v39, v45
    v_permlane32_swap_b32 v40, v46
    v_permlane32_swap_b32 v41, v47
    v_add_f32 v36, v36, v42
    v_add_f32 v37, v37, v43
    v_add_f32 v38, v38, v44
    v_add_f32 v39, v39, v45
    v_add_f32 v40, v40, v46
    v_add_f32 v41, v41, v47
    s_lshl_b32 s67, s52, 8
    v_lshrrev_b32 v10, 8, v16
    v_mov_b32 v11, 768
    v_mad_u32_u24 v10, v10, v11, v16
    v_add_u32 v10, s67, v10
    ds_write_b32 v10, v36 offset:6720
    v_lshrrev_b32 v10, 8, v17
    v_mov_b32 v11, 768
    v_mad_u32_u24 v10, v10, v11, v17
    v_add_u32 v10, s67, v10
    ds_write_b32 v10, v37 offset:6720
    v_lshrrev_b32 v10, 8, v18
    v_mov_b32 v11, 768
    v_mad_u32_u24 v10, v10, v11, v18
    v_add_u32 v10, s67, v10
    ds_write_b32 v10, v38 offset:6720
    v_lshrrev_b32 v10, 8, v19
    v_mov_b32 v11, 768
    v_mad_u32_u24 v10, v10, v11, v19
    v_add_u32 v10, s67, v10
    ds_write_b32 v10, v39 offset:6720
    v_lshrrev_b32 v10, 8, v20
    v_mov_b32 v11, 768
    v_mad_u32_u24 v10, v10, v11, v20
    v_add_u32 v10, s67, v10
    ds_write_b32 v10, v40 offset:6720
    v_lshrrev_b32 v10, 8, v21
    v_mov_b32 v11, 768
    v_mad_u32_u24 v10, v10, v11, v21
    v_add_u32 v10, s67, v10
    ds_write_b32 v10, v41 offset:6720
    s_waitcnt lgkmcnt(0)
    s_barrier
    s_lshl_b32 s67, s53, 9
    s_add_u32 s67, s67, 2359296
    v_add_u32 v156, 0, v0
    v_lshlrev_b32 v157, 3, v156
    ds_read_b64 v[160:161], v157 offset:6720
    v_lshrrev_b32 v158, 5, v156
    v_lshlrev_b32 v158, 14, v158
    v_and_b32 v159, 31, v156
    v_lshl_add_u32 v158, v159, 4, v158
    s_waitcnt lgkmcnt(0)
    v_mov_b32 v164, v160
    v_mov_b32 v165, s62
    v_mov_b32 v166, v161
    v_mov_b32 v167, s63
    buffer_store_dwordx4 v[164:167], v158, s[40:43], s67 offen sc1
    s_cmp_lg_u32 s52, 0
    s_cbranch_scc1 L_ffn_pub_done
    v_add_u32 v156, 256, v0
    v_lshlrev_b32 v157, 3, v156
    ds_read_b64 v[160:161], v157 offset:6720
    v_lshrrev_b32 v158, 5, v156
    v_lshlrev_b32 v158, 14, v158
    v_and_b32 v159, 31, v156
    v_lshl_add_u32 v158, v159, 4, v158
    s_waitcnt lgkmcnt(0)
    v_mov_b32 v168, v160
    v_mov_b32 v169, s62
    v_mov_b32 v170, v161
    v_mov_b32 v171, s63
    buffer_store_dwordx4 v[168:171], v158, s[40:43], s67 offen sc1
L_ffn_pub_done:
L_main:
    v_mov_b32 v4, 0xff800000
    v_mov_b32 v5, 0
    v_mov_b32 v36, 0
    v_mov_b32 v37, 0
    v_mov_b32 v38, 0
    v_mov_b32 v39, 0
    v_mov_b32 v40, 0
    v_mov_b32 v41, 0
    v_mov_b32 v42, 0
    v_mov_b32 v43, 0
    v_mov_b32 v44, 0
    v_mov_b32 v45, 0
    v_mov_b32 v46, 0
    v_mov_b32 v47, 0
    v_mov_b32 v48, 0
    v_mov_b32 v49, 0
    v_mov_b32 v50, 0
    v_mov_b32 v51, 0
    v_mov_b32 v52, 0
    v_mov_b32 v53, 0
    v_mov_b32 v54, 0
    v_mov_b32 v55, 0
    v_mov_b32 v56, 0
    v_mov_b32 v57, 0
    v_mov_b32 v58, 0
    v_mov_b32 v59, 0
    s_waitcnt lgkmcnt(0)
    s_mov_b32 s13, 1
    s_mov_b32 s12, 1
.p2align 6
L_loop:
    s_waitcnt vmcnt(21)
    s_add_u32 s67, s55, 1
    s_add_u32 s68, s56, 32
    s_add_u32 s56, s56, s100
    s_cmp_lt_u32 s67, 20
    s_cselect_b32 s56, s68, s56
    s_cmp_eq_u32 s67, 20
    s_cselect_b32 s56, s7, s56
    s_lshl_b32 s10, s56, 1
    s_mov_b32 s11, 1
    s_cmp_lt_u32 s67, s3
    s_cbranch_scc1 L_st
    v_readfirstlane_b32 s10, v14
    s_mov_b32 s11, s12
    s_sub_u32 s10, s10, s61
    s_add_u32 s10, s10, s101
L_st:
    s_cmp_ge_u32 s10, 2048
    s_cbranch_scc1 L_drain
    s_lshr_b32 s58, s10, 1
    s_mul_i32 s58, s58, 12288
    s_and_b32 s68, s10, 1
    s_mul_i32 s68, s68, 768
    s_add_u32 s58, s58, s68
    s_add_u32 s58, s58, s57
    s_mov_b32 s14, 0
    s_add_u32 s67, s55, 2
    s_cmp_lt_u32 s67, s3
    s_cbranch_scc1 L_noat
    s_cmp_ge_u32 s10, 1920
    s_cselect_b32 s14, 1, 0
    s_cselect_b32 s12, 0, 1
    s_cselect_b32 s67, 1, 2
    v_mov_b32 v14, s67
    s_mov_b64 exec, 1
    buffer_atomic_add v14, v3, s[40:43], s60 offen sc0 nt
    s_mov_b64 exec, -1
L_noat:
    s_add_u32 s55, s55, 1
    v_mov_b32 v8, 0
    v_mov_b32 v9, 0
    v_dot2c_f32_bf16 v8, v60, v24
    v_dot2c_f32_bf16 v9, v61, v25
    v_dot2c_f32_bf16 v8, v62, v26
    v_dot2c_f32_bf16 v9, v63, v27
    v_dot2c_f32_bf16 v8, v64, v28
    v_dot2c_f32_bf16 v9, v65, v29
    v_dot2c_f32_bf16 v8, v66, v30
    v_dot2c_f32_bf16 v9, v67, v31
    v_dot2c_f32_bf16 v8, v68, v32
    v_dot2c_f32_bf16 v9, v69, v33
    v_dot2c_f32_bf16 v8, v70, v34
    v_dot2c_f32_bf16 v9, v71, v35
    buffer_load_dwordx4 v[60:63], v2, s[32:35], s58 offen offset:0 nt
    buffer_load_dwordx4 v[64:67], v2, s[32:35], s58 offen offset:128 nt
    buffer_load_dwordx4 v[68:71], v2, s[32:35], s58 offen offset:256 nt
    v_add_f32 v8, v8, v9
    s_nop 1
    v_add_f32_dpp v8, v8, v8 quad_perm:[1,0,3,2] row_mask:0xf bank_mask:0xf
    s_nop 1
    v_add_f32_dpp v8, v8, v8 quad_perm:[2,3,0,1] row_mask:0xf bank_mask:0xf
    s_nop 1
    v_add_f32_dpp v8, v8, v8 row_half_mirror row_mask:0xf bank_mask:0xf
    v_cvt_pk_bf16_f32 v8, v8, v8
    v_and_b32 v8, s66, v8
    v_mul_f32 v8, s64, v8
    v_cvt_pk_bf16_f32 v8, v8, v8
    v_and_b32 v8, s66, v8
    v_max_f32 v10, v4, v8
    v_sub_f32 v6, v4, v10
    v_sub_f32 v8, v8, v10
    v_mul_f32 v6, s65, v6
    v_mul_f32 v8, s65, v8
    v_exp_f32 v6, v6
    v_exp_f32 v8, v8
    v_mov_b32 v4, v10
    v_fma_f32 v5, v5, v6, v8
    v_pk_mul_f32 v[36:37], v[36:37], v[6:7] op_sel_hi:[1,0]
    v_pk_mul_f32 v[38:39], v[38:39], v[6:7] op_sel_hi:[1,0]
    v_pk_mul_f32 v[40:41], v[40:41], v[6:7] op_sel_hi:[1,0]
    v_pk_mul_f32 v[42:43], v[42:43], v[6:7] op_sel_hi:[1,0]
    v_pk_mul_f32 v[44:45], v[44:45], v[6:7] op_sel_hi:[1,0]
    v_pk_mul_f32 v[46:47], v[46:47], v[6:7] op_sel_hi:[1,0]
    v_pk_mul_f32 v[48:49], v[48:49], v[6:7] op_sel_hi:[1,0]
    v_pk_mul_f32 v[50:51], v[50:51], v[6:7] op_sel_hi:[1,0]
    v_pk_mul_f32 v[52:53], v[52:53], v[6:7] op_sel_hi:[1,0]
    v_pk_mul_f32 v[54:55], v[54:55], v[6:7] op_sel_hi:[1,0]
    v_pk_mul_f32 v[56:57], v[56:57], v[6:7] op_sel_hi:[1,0]
    v_pk_mul_f32 v[58:59], v[58:59], v[6:7] op_sel_hi:[1,0]
    s_waitcnt vmcnt(21)
    v_lshlrev_b32 v10, 16, v108
    v_and_b32 v11, s66, v108
    v_pk_fma_f32 v[36:37], v[10:11], v[8:9], v[36:37] op_sel_hi:[1,0,1]
    v_lshlrev_b32 v12, 16, v109
    v_and_b32 v13, s66, v109
    v_pk_fma_f32 v[38:39], v[12:13], v[8:9], v[38:39] op_sel_hi:[1,0,1]
    v_lshlrev_b32 v10, 16, v110
    v_and_b32 v11, s66, v110
    v_pk_fma_f32 v[40:41], v[10:11], v[8:9], v[40:41] op_sel_hi:[1,0,1]
    v_lshlrev_b32 v12, 16, v111
    v_and_b32 v13, s66, v111
    v_pk_fma_f32 v[42:43], v[12:13], v[8:9], v[42:43] op_sel_hi:[1,0,1]
    v_lshlrev_b32 v10, 16, v112
    v_and_b32 v11, s66, v112
    v_pk_fma_f32 v[44:45], v[10:11], v[8:9], v[44:45] op_sel_hi:[1,0,1]
    v_lshlrev_b32 v12, 16, v113
    v_and_b32 v13, s66, v113
    v_pk_fma_f32 v[46:47], v[12:13], v[8:9], v[46:47] op_sel_hi:[1,0,1]
    v_lshlrev_b32 v10, 16, v114
    v_and_b32 v11, s66, v114
    v_pk_fma_f32 v[48:49], v[10:11], v[8:9], v[48:49] op_sel_hi:[1,0,1]
    v_lshlrev_b32 v12, 16, v115
    v_and_b32 v13, s66, v115
    v_pk_fma_f32 v[50:51], v[12:13], v[8:9], v[50:51] op_sel_hi:[1,0,1]
    v_lshlrev_b32 v10, 16, v116
    v_and_b32 v11, s66, v116
    v_pk_fma_f32 v[52:53], v[10:11], v[8:9], v[52:53] op_sel_hi:[1,0,1]
    v_lshlrev_b32 v12, 16, v117
    v_and_b32 v13, s66, v117
    v_pk_fma_f32 v[54:55], v[12:13], v[8:9], v[54:55] op_sel_hi:[1,0,1]
    v_lshlrev_b32 v10, 16, v118
    v_and_b32 v11, s66, v118
    v_pk_fma_f32 v[56:57], v[10:11], v[8:9], v[56:57] op_sel_hi:[1,0,1]
    v_lshlrev_b32 v12, 16, v119
    v_and_b32 v13, s66, v119
    v_pk_fma_f32 v[58:59], v[12:13], v[8:9], v[58:59] op_sel_hi:[1,0,1]
    buffer_load_dwordx4 v[108:111], v2, s[36:39], s58 offen offset:0 nt
    buffer_load_dwordx4 v[112:115], v2, s[36:39], s58 offen offset:128 nt
    buffer_load_dwordx4 v[116:119], v2, s[36:39], s58 offen offset:256 nt
    s_waitcnt vmcnt(21)
    v_mov_b32 v8, 0
    v_mov_b32 v9, 0
    v_dot2c_f32_bf16 v8, v72, v24
    v_dot2c_f32_bf16 v9, v73, v25
    v_dot2c_f32_bf16 v8, v74, v26
    v_dot2c_f32_bf16 v9, v75, v27
    v_dot2c_f32_bf16 v8, v76, v28
    v_dot2c_f32_bf16 v9, v77, v29
    v_dot2c_f32_bf16 v8, v78, v30
    v_dot2c_f32_bf16 v9, v79, v31
    v_dot2c_f32_bf16 v8, v80, v32
    v_dot2c_f32_bf16 v9, v81, v33
    v_dot2c_f32_bf16 v8, v82, v34
    v_dot2c_f32_bf16 v9, v83, v35
    buffer_load_dwordx4 v[72:75], v2, s[32:35], s58 offen offset:384 nt
    buffer_load_dwordx4 v[76:79], v2, s[32:35], s58 offen offset:512 nt
    buffer_load_dwordx4 v[80:83], v2, s[32:35], s58 offen offset:640 nt
    v_add_f32 v8, v8, v9
    s_nop 1
    v_add_f32_dpp v8, v8, v8 quad_perm:[1,0,3,2] row_mask:0xf bank_mask:0xf
    s_nop 1
    v_add_f32_dpp v8, v8, v8 quad_perm:[2,3,0,1] row_mask:0xf bank_mask:0xf
    s_nop 1
    v_add_f32_dpp v8, v8, v8 row_half_mirror row_mask:0xf bank_mask:0xf
    v_cvt_pk_bf16_f32 v8, v8, v8
    v_and_b32 v8, s66, v8
    v_mul_f32 v8, s64, v8
    v_cvt_pk_bf16_f32 v8, v8, v8
    v_and_b32 v8, s66, v8
    v_max_f32 v10, v4, v8
    v_sub_f32 v6, v4, v10
    v_sub_f32 v8, v8, v10
    v_mul_f32 v6, s65, v6
    v_mul_f32 v8, s65, v8
    v_exp_f32 v6, v6
    v_exp_f32 v8, v8
    v_mov_b32 v4, v10
    v_fma_f32 v5, v5, v6, v8
    v_pk_mul_f32 v[36:37], v[36:37], v[6:7] op_sel_hi:[1,0]
    v_pk_mul_f32 v[38:39], v[38:39], v[6:7] op_sel_hi:[1,0]
    v_pk_mul_f32 v[40:41], v[40:41], v[6:7] op_sel_hi:[1,0]
    v_pk_mul_f32 v[42:43], v[42:43], v[6:7] op_sel_hi:[1,0]
    v_pk_mul_f32 v[44:45], v[44:45], v[6:7] op_sel_hi:[1,0]
    v_pk_mul_f32 v[46:47], v[46:47], v[6:7] op_sel_hi:[1,0]
    v_pk_mul_f32 v[48:49], v[48:49], v[6:7] op_sel_hi:[1,0]
    v_pk_mul_f32 v[50:51], v[50:51], v[6:7] op_sel_hi:[1,0]
    v_pk_mul_f32 v[52:53], v[52:53], v[6:7] op_sel_hi:[1,0]
    v_pk_mul_f32 v[54:55], v[54:55], v[6:7] op_sel_hi:[1,0]
    v_pk_mul_f32 v[56:57], v[56:57], v[6:7] op_sel_hi:[1,0]
    v_pk_mul_f32 v[58:59], v[58:59], v[6:7] op_sel_hi:[1,0]
    s_waitcnt vmcnt(21)
    v_lshlrev_b32 v10, 16, v120
    v_and_b32 v11, s66, v120
    v_pk_fma_f32 v[36:37], v[10:11], v[8:9], v[36:37] op_sel_hi:[1,0,1]
    v_lshlrev_b32 v12, 16, v121
    v_and_b32 v13, s66, v121
    v_pk_fma_f32 v[38:39], v[12:13], v[8:9], v[38:39] op_sel_hi:[1,0,1]
    v_lshlrev_b32 v10, 16, v122
    v_and_b32 v11, s66, v122
    v_pk_fma_f32 v[40:41], v[10:11], v[8:9], v[40:41] op_sel_hi:[1,0,1]
    v_lshlrev_b32 v12, 16, v123
    v_and_b32 v13, s66, v123
    v_pk_fma_f32 v[42:43], v[12:13], v[8:9], v[42:43] op_sel_hi:[1,0,1]
    v_lshlrev_b32 v10, 16, v124
    v_and_b32 v11, s66, v124
    v_pk_fma_f32 v[44:45], v[10:11], v[8:9], v[44:45] op_sel_hi:[1,0,1]
    v_lshlrev_b32 v12, 16, v125
    v_and_b32 v13, s66, v125
    v_pk_fma_f32 v[46:47], v[12:13], v[8:9], v[46:47] op_sel_hi:[1,0,1]
    v_lshlrev_b32 v10, 16, v126
    v_and_b32 v11, s66, v126
    v_pk_fma_f32 v[48:49], v[10:11], v[8:9], v[48:49] op_sel_hi:[1,0,1]
    v_lshlrev_b32 v12, 16, v127
    v_and_b32 v13, s66, v127
    v_pk_fma_f32 v[50:51], v[12:13], v[8:9], v[50:51] op_sel_hi:[1,0,1]
    v_lshlrev_b32 v10, 16, v128
    v_and_b32 v11, s66, v128
    v_pk_fma_f32 v[52:53], v[10:11], v[8:9], v[52:53] op_sel_hi:[1,0,1]
    v_lshlrev_b32 v12, 16, v129
    v_and_b32 v13, s66, v129
    v_pk_fma_f32 v[54:55], v[12:13], v[8:9], v[54:55] op_sel_hi:[1,0,1]
    v_lshlrev_b32 v10, 16, v130
    v_and_b32 v11, s66, v130
    v_pk_fma_f32 v[56:57], v[10:11], v[8:9], v[56:57] op_sel_hi:[1,0,1]
    v_lshlrev_b32 v12, 16, v131
    v_and_b32 v13, s66, v131
    v_pk_fma_f32 v[58:59], v[12:13], v[8:9], v[58:59] op_sel_hi:[1,0,1]
    buffer_load_dwordx4 v[120:123], v2, s[36:39], s58 offen offset:384 nt
    buffer_load_dwordx4 v[124:127], v2, s[36:39], s58 offen offset:512 nt
    buffer_load_dwordx4 v[128:131], v2, s[36:39], s58 offen offset:640 nt
    s_waitcnt vmcnt(21)
    s_add_u32 s10, s10, 1
    s_cmp_lg_u32 s11, 0
    s_cbranch_scc1 L_bpair
    v_readfirstlane_b32 s10, v15
    s_nop 0
    s_sub_u32 s10, s10, s61
    s_add_u32 s10, s10, s101
L_bpair:
    s_lshr_b32 s59, s10, 1
    s_mul_i32 s59, s59, 12288
    s_and_b32 s68, s10, 1
    s_mul_i32 s68, s68, 768
    s_add_u32 s59, s59, s68
    s_add_u32 s59, s59, s57
    s_cmp_lt_u32 s10, 2048
    s_cselect_b32 s13, 1, 0
    s_cselect_b32 s59, s59, s58
    s_cselect_b32 s68, 0, 1073741824
    v_add_u32 v22, s68, v2
    s_cmp_eq_u32 s14, 0
    s_cbranch_scc1 L_nobat
    v_mov_b32 v15, 1
    s_mov_b64 exec, 1
    buffer_atomic_add v15, v3, s[40:43], s60 offen sc0 nt
    s_mov_b64 exec, -1
L_nobat:
    v_mov_b32 v8, 0
    v_mov_b32 v9, 0
    v_dot2c_f32_bf16 v8, v84, v24
    v_dot2c_f32_bf16 v9, v85, v25
    v_dot2c_f32_bf16 v8, v86, v26
    v_dot2c_f32_bf16 v9, v87, v27
    v_dot2c_f32_bf16 v8, v88, v28
    v_dot2c_f32_bf16 v9, v89, v29
    v_dot2c_f32_bf16 v8, v90, v30
    v_dot2c_f32_bf16 v9, v91, v31
    v_dot2c_f32_bf16 v8, v92, v32
    v_dot2c_f32_bf16 v9, v93, v33
    v_dot2c_f32_bf16 v8, v94, v34
    v_dot2c_f32_bf16 v9, v95, v35
    buffer_load_dwordx4 v[84:87], v22, s[32:35], s59 offen offset:0 nt
    buffer_load_dwordx4 v[88:91], v22, s[32:35], s59 offen offset:128 nt
    buffer_load_dwordx4 v[92:95], v22, s[32:35], s59 offen offset:256 nt
    v_add_f32 v8, v8, v9
    s_nop 1
    v_add_f32_dpp v8, v8, v8 quad_perm:[1,0,3,2] row_mask:0xf bank_mask:0xf
    s_nop 1
    v_add_f32_dpp v8, v8, v8 quad_perm:[2,3,0,1] row_mask:0xf bank_mask:0xf
    s_nop 1
    v_add_f32_dpp v8, v8, v8 row_half_mirror row_mask:0xf bank_mask:0xf
    v_cvt_pk_bf16_f32 v8, v8, v8
    v_and_b32 v8, s66, v8
    v_mul_f32 v8, s64, v8
    v_cvt_pk_bf16_f32 v8, v8, v8
    v_and_b32 v8, s66, v8
    v_max_f32 v10, v4, v8
    v_sub_f32 v6, v4, v10
    v_sub_f32 v8, v8, v10
    v_mul_f32 v6, s65, v6
    v_mul_f32 v8, s65, v8
    v_exp_f32 v6, v6
    v_exp_f32 v8, v8
    v_mov_b32 v4, v10
    v_fma_f32 v5, v5, v6, v8
    v_pk_mul_f32 v[36:37], v[36:37], v[6:7] op_sel_hi:[1,0]
    v_pk_mul_f32 v[38:39], v[38:39], v[6:7] op_sel_hi:[1,0]
    v_pk_mul_f32 v[40:41], v[40:41], v[6:7] op_sel_hi:[1,0]
    v_pk_mul_f32 v[42:43], v[42:43], v[6:7] op_sel_hi:[1,0]
    v_pk_mul_f32 v[44:45], v[44:45], v[6:7] op_sel_hi:[1,0]
    v_pk_mul_f32 v[46:47], v[46:47], v[6:7] op_sel_hi:[1,0]
    v_pk_mul_f32 v[48:49], v[48:49], v[6:7] op_sel_hi:[1,0]
    v_pk_mul_f32 v[50:51], v[50:51], v[6:7] op_sel_hi:[1,0]
    v_pk_mul_f32 v[52:53], v[52:53], v[6:7] op_sel_hi:[1,0]
    v_pk_mul_f32 v[54:55], v[54:55], v[6:7] op_sel_hi:[1,0]
    v_pk_mul_f32 v[56:57], v[56:57], v[6:7] op_sel_hi:[1,0]
    v_pk_mul_f32 v[58:59], v[58:59], v[6:7] op_sel_hi:[1,0]
    s_waitcnt vmcnt(21)
    v_lshlrev_b32 v10, 16, v132
    v_and_b32 v11, s66, v132
    v_pk_fma_f32 v[36:37], v[10:11], v[8:9], v[36:37] op_sel_hi:[1,0,1]
    v_lshlrev_b32 v12, 16, v133
    v_and_b32 v13, s66, v133
    v_pk_fma_f32 v[38:39], v[12:13], v[8:9], v[38:39] op_sel_hi:[1,0,1]
    v_lshlrev_b32 v10, 16, v134
    v_and_b32 v11, s66, v134
    v_pk_fma_f32 v[40:41], v[10:11], v[8:9], v[40:41] op_sel_hi:[1,0,1]
    v_lshlrev_b32 v12, 16, v135
    v_and_b32 v13, s66, v135
    v_pk_fma_f32 v[42:43], v[12:13], v[8:9], v[42:43] op_sel_hi:[1,0,1]
    v_lshlrev_b32 v10, 16, v136
    v_and_b32 v11, s66, v136
    v_pk_fma_f32 v[44:45], v[10:11], v[8:9], v[44:45] op_sel_hi:[1,0,1]
    v_lshlrev_b32 v12, 16, v137
    v_and_b32 v13, s66, v137
    v_pk_fma_f32 v[46:47], v[12:13], v[8:9], v[46:47] op_sel_hi:[1,0,1]
    v_lshlrev_b32 v10, 16, v138
    v_and_b32 v11, s66, v138
    v_pk_fma_f32 v[48:49], v[10:11], v[8:9], v[48:49] op_sel_hi:[1,0,1]
    v_lshlrev_b32 v12, 16, v139
    v_and_b32 v13, s66, v139
    v_pk_fma_f32 v[50:51], v[12:13], v[8:9], v[50:51] op_sel_hi:[1,0,1]
    v_lshlrev_b32 v10, 16, v140
    v_and_b32 v11, s66, v140
    v_pk_fma_f32 v[52:53], v[10:11], v[8:9], v[52:53] op_sel_hi:[1,0,1]
    v_lshlrev_b32 v12, 16, v141
    v_and_b32 v13, s66, v141
    v_pk_fma_f32 v[54:55], v[12:13], v[8:9], v[54:55] op_sel_hi:[1,0,1]
    v_lshlrev_b32 v10, 16, v142
    v_and_b32 v11, s66, v142
    v_pk_fma_f32 v[56:57], v[10:11], v[8:9], v[56:57] op_sel_hi:[1,0,1]
    v_lshlrev_b32 v12, 16, v143
    v_and_b32 v13, s66, v143
    v_pk_fma_f32 v[58:59], v[12:13], v[8:9], v[58:59] op_sel_hi:[1,0,1]
    buffer_load_dwordx4 v[132:135], v22, s[36:39], s59 offen offset:0 nt
    buffer_load_dwordx4 v[136:139], v22, s[36:39], s59 offen offset:128 nt
    buffer_load_dwordx4 v[140:143], v22, s[36:39], s59 offen offset:256 nt
    s_waitcnt vmcnt(21)
    v_mov_b32 v8, 0
    v_mov_b32 v9, 0
    v_dot2c_f32_bf16 v8, v96, v24
    v_dot2c_f32_bf16 v9, v97, v25
    v_dot2c_f32_bf16 v8, v98, v26
    v_dot2c_f32_bf16 v9, v99, v27
    v_dot2c_f32_bf16 v8, v100, v28
    v_dot2c_f32_bf16 v9, v101, v29
    v_dot2c_f32_bf16 v8, v102, v30
    v_dot2c_f32_bf16 v9, v103, v31
    v_dot2c_f32_bf16 v8, v104, v32
    v_dot2c_f32_bf16 v9, v105, v33
    v_dot2c_f32_bf16 v8, v106, v34
    v_dot2c_f32_bf16 v9, v107, v35
    buffer_load_dwordx4 v[96:99], v22, s[32:35], s59 offen offset:384 nt
    buffer_load_dwordx4 v[100:103], v22, s[32:35], s59 offen offset:512 nt
    buffer_load_dwordx4 v[104:107], v22, s[32:35], s59 offen offset:640 nt
    v_add_f32 v8, v8, v9
    s_nop 1
    v_add_f32_dpp v8, v8, v8 quad_perm:[1,0,3,2] row_mask:0xf bank_mask:0xf
    s_nop 1
    v_add_f32_dpp v8, v8, v8 quad_perm:[2,3,0,1] row_mask:0xf bank_mask:0xf
    s_nop 1
    v_add_f32_dpp v8, v8, v8 row_half_mirror row_mask:0xf bank_mask:0xf
    v_cvt_pk_bf16_f32 v8, v8, v8
    v_and_b32 v8, s66, v8
    v_mul_f32 v8, s64, v8
    v_cvt_pk_bf16_f32 v8, v8, v8
    v_and_b32 v8, s66, v8
    v_max_f32 v10, v4, v8
    v_sub_f32 v6, v4, v10
    v_sub_f32 v8, v8, v10
    v_mul_f32 v6, s65, v6
    v_mul_f32 v8, s65, v8
    v_exp_f32 v6, v6
    v_exp_f32 v8, v8
    v_mov_b32 v4, v10
    v_fma_f32 v5, v5, v6, v8
    v_pk_mul_f32 v[36:37], v[36:37], v[6:7] op_sel_hi:[1,0]
    v_pk_mul_f32 v[38:39], v[38:39], v[6:7] op_sel_hi:[1,0]
    v_pk_mul_f32 v[40:41], v[40:41], v[6:7] op_sel_hi:[1,0]
    v_pk_mul_f32 v[42:43], v[42:43], v[6:7] op_sel_hi:[1,0]
    v_pk_mul_f32 v[44:45], v[44:45], v[6:7] op_sel_hi:[1,0]
    v_pk_mul_f32 v[46:47], v[46:47], v[6:7] op_sel_hi:[1,0]
    v_pk_mul_f32 v[48:49], v[48:49], v[6:7] op_sel_hi:[1,0]
    v_pk_mul_f32 v[50:51], v[50:51], v[6:7] op_sel_hi:[1,0]
    v_pk_mul_f32 v[52:53], v[52:53], v[6:7] op_sel_hi:[1,0]
    v_pk_mul_f32 v[54:55], v[54:55], v[6:7] op_sel_hi:[1,0]
    v_pk_mul_f32 v[56:57], v[56:57], v[6:7] op_sel_hi:[1,0]
    v_pk_mul_f32 v[58:59], v[58:59], v[6:7] op_sel_hi:[1,0]
    s_waitcnt vmcnt(21)
    v_lshlrev_b32 v10, 16, v144
    v_and_b32 v11, s66, v144
    v_pk_fma_f32 v[36:37], v[10:11], v[8:9], v[36:37] op_sel_hi:[1,0,1]
    v_lshlrev_b32 v12, 16, v145
    v_and_b32 v13, s66, v145
    v_pk_fma_f32 v[38:39], v[12:13], v[8:9], v[38:39] op_sel_hi:[1,0,1]
    v_lshlrev_b32 v10, 16, v146
    v_and_b32 v11, s66, v146
    v_pk_fma_f32 v[40:41], v[10:11], v[8:9], v[40:41] op_sel_hi:[1,0,1]
    v_lshlrev_b32 v12, 16, v147
    v_and_b32 v13, s66, v147
    v_pk_fma_f32 v[42:43], v[12:13], v[8:9], v[42:43] op_sel_hi:[1,0,1]
    v_lshlrev_b32 v10, 16, v148
    v_and_b32 v11, s66, v148
    v_pk_fma_f32 v[44:45], v[10:11], v[8:9], v[44:45] op_sel_hi:[1,0,1]
    v_lshlrev_b32 v12, 16, v149
    v_and_b32 v13, s66, v149
    v_pk_fma_f32 v[46:47], v[12:13], v[8:9], v[46:47] op_sel_hi:[1,0,1]
    v_lshlrev_b32 v10, 16, v150
    v_and_b32 v11, s66, v150
    v_pk_fma_f32 v[48:49], v[10:11], v[8:9], v[48:49] op_sel_hi:[1,0,1]
    v_lshlrev_b32 v12, 16, v151
    v_and_b32 v13, s66, v151
    v_pk_fma_f32 v[50:51], v[12:13], v[8:9], v[50:51] op_sel_hi:[1,0,1]
    v_lshlrev_b32 v10, 16, v152
    v_and_b32 v11, s66, v152
    v_pk_fma_f32 v[52:53], v[10:11], v[8:9], v[52:53] op_sel_hi:[1,0,1]
    v_lshlrev_b32 v12, 16, v153
    v_and_b32 v13, s66, v153
    v_pk_fma_f32 v[54:55], v[12:13], v[8:9], v[54:55] op_sel_hi:[1,0,1]
    v_lshlrev_b32 v10, 16, v154
    v_and_b32 v11, s66, v154
    v_pk_fma_f32 v[56:57], v[10:11], v[8:9], v[56:57] op_sel_hi:[1,0,1]
    v_lshlrev_b32 v12, 16, v155
    v_and_b32 v13, s66, v155
    v_pk_fma_f32 v[58:59], v[12:13], v[8:9], v[58:59] op_sel_hi:[1,0,1]
    buffer_load_dwordx4 v[144:147], v22, s[36:39], s59 offen offset:384 nt
    buffer_load_dwordx4 v[148:151], v22, s[36:39], s59 offen offset:512 nt
    buffer_load_dwordx4 v[152:155], v22, s[36:39], s59 offen offset:640 nt
    s_branch L_loop
L_drain:
    v_mov_b32 v8, 0
    v_mov_b32 v9, 0
    v_dot2c_f32_bf16 v8, v60, v24
    v_dot2c_f32_bf16 v9, v61, v25
    v_dot2c_f32_bf16 v8, v62, v26
    v_dot2c_f32_bf16 v9, v63, v27
    v_dot2c_f32_bf16 v8, v64, v28
    v_dot2c_f32_bf16 v9, v65, v29
    v_dot2c_f32_bf16 v8, v66, v30
    v_dot2c_f32_bf16 v9, v67, v31
    v_dot2c_f32_bf16 v8, v68, v32
    v_dot2c_f32_bf16 v9, v69, v33
    v_dot2c_f32_bf16 v8, v70, v34
    v_dot2c_f32_bf16 v9, v71, v35
    s_nop 2
    v_add_f32 v8, v8, v9
    s_nop 1
    v_add_f32_dpp v8, v8, v8 quad_perm:[1,0,3,2] row_mask:0xf bank_mask:0xf
    s_nop 1
    v_add_f32_dpp v8, v8, v8 quad_perm:[2,3,0,1] row_mask:0xf bank_mask:0xf
    s_nop 1
    v_add_f32_dpp v8, v8, v8 row_half_mirror row_mask:0xf bank_mask:0xf
    v_cvt_pk_bf16_f32 v8, v8, v8
    v_and_b32 v8, s66, v8
    v_mul_f32 v8, s64, v8
    v_cvt_pk_bf16_f32 v8, v8, v8
    v_and_b32 v8, s66, v8
    v_max_f32 v10, v4, v8
    v_sub_f32 v6, v4, v10
    v_sub_f32 v8, v8, v10
    v_mul_f32 v6, s65, v6
    v_mul_f32 v8, s65, v8
    v_exp_f32 v6, v6
    v_exp_f32 v8, v8
    v_mov_b32 v4, v10
    v_fma_f32 v5, v5, v6, v8
    v_pk_mul_f32 v[36:37], v[36:37], v[6:7] op_sel_hi:[1,0]
    v_pk_mul_f32 v[38:39], v[38:39], v[6:7] op_sel_hi:[1,0]
    v_pk_mul_f32 v[40:41], v[40:41], v[6:7] op_sel_hi:[1,0]
    v_pk_mul_f32 v[42:43], v[42:43], v[6:7] op_sel_hi:[1,0]
    v_pk_mul_f32 v[44:45], v[44:45], v[6:7] op_sel_hi:[1,0]
    v_pk_mul_f32 v[46:47], v[46:47], v[6:7] op_sel_hi:[1,0]
    v_pk_mul_f32 v[48:49], v[48:49], v[6:7] op_sel_hi:[1,0]
    v_pk_mul_f32 v[50:51], v[50:51], v[6:7] op_sel_hi:[1,0]
    v_pk_mul_f32 v[52:53], v[52:53], v[6:7] op_sel_hi:[1,0]
    v_pk_mul_f32 v[54:55], v[54:55], v[6:7] op_sel_hi:[1,0]
    v_pk_mul_f32 v[56:57], v[56:57], v[6:7] op_sel_hi:[1,0]
    v_pk_mul_f32 v[58:59], v[58:59], v[6:7] op_sel_hi:[1,0]
    s_waitcnt vmcnt(18)
    v_lshlrev_b32 v10, 16, v108
    v_and_b32 v11, s66, v108
    v_pk_fma_f32 v[36:37], v[10:11], v[8:9], v[36:37] op_sel_hi:[1,0,1]
    v_lshlrev_b32 v12, 16, v109
    v_and_b32 v13, s66, v109
    v_pk_fma_f32 v[38:39], v[12:13], v[8:9], v[38:39] op_sel_hi:[1,0,1]
    v_lshlrev_b32 v10, 16, v110
    v_and_b32 v11, s66, v110
    v_pk_fma_f32 v[40:41], v[10:11], v[8:9], v[40:41] op_sel_hi:[1,0,1]
    v_lshlrev_b32 v12, 16, v111
    v_and_b32 v13, s66, v111
    v_pk_fma_f32 v[42:43], v[12:13], v[8:9], v[42:43] op_sel_hi:[1,0,1]
    v_lshlrev_b32 v10, 16, v112
    v_and_b32 v11, s66, v112
    v_pk_fma_f32 v[44:45], v[10:11], v[8:9], v[44:45] op_sel_hi:[1,0,1]
    v_lshlrev_b32 v12, 16, v113
    v_and_b32 v13, s66, v113
    v_pk_fma_f32 v[46:47], v[12:13], v[8:9], v[46:47] op_sel_hi:[1,0,1]
    v_lshlrev_b32 v10, 16, v114
    v_and_b32 v11, s66, v114
    v_pk_fma_f32 v[48:49], v[10:11], v[8:9], v[48:49] op_sel_hi:[1,0,1]
    v_lshlrev_b32 v12, 16, v115
    v_and_b32 v13, s66, v115
    v_pk_fma_f32 v[50:51], v[12:13], v[8:9], v[50:51] op_sel_hi:[1,0,1]
    v_lshlrev_b32 v10, 16, v116
    v_and_b32 v11, s66, v116
    v_pk_fma_f32 v[52:53], v[10:11], v[8:9], v[52:53] op_sel_hi:[1,0,1]
    v_lshlrev_b32 v12, 16, v117
    v_and_b32 v13, s66, v117
    v_pk_fma_f32 v[54:55], v[12:13], v[8:9], v[54:55] op_sel_hi:[1,0,1]
    v_lshlrev_b32 v10, 16, v118
    v_and_b32 v11, s66, v118
    v_pk_fma_f32 v[56:57], v[10:11], v[8:9], v[56:57] op_sel_hi:[1,0,1]
    v_lshlrev_b32 v12, 16, v119
    v_and_b32 v13, s66, v119
    v_pk_fma_f32 v[58:59], v[12:13], v[8:9], v[58:59] op_sel_hi:[1,0,1]
    s_waitcnt vmcnt(15)
    v_mov_b32 v8, 0
    v_mov_b32 v9, 0
    v_dot2c_f32_bf16 v8, v72, v24
    v_dot2c_f32_bf16 v9, v73, v25
    v_dot2c_f32_bf16 v8, v74, v26
    v_dot2c_f32_bf16 v9, v75, v27
    v_dot2c_f32_bf16 v8, v76, v28
    v_dot2c_f32_bf16 v9, v77, v29
    v_dot2c_f32_bf16 v8, v78, v30
    v_dot2c_f32_bf16 v9, v79, v31
    v_dot2c_f32_bf16 v8, v80, v32
    v_dot2c_f32_bf16 v9, v81, v33
    v_dot2c_f32_bf16 v8, v82, v34
    v_dot2c_f32_bf16 v9, v83, v35
    s_nop 2
    v_add_f32 v8, v8, v9
    s_nop 1
    v_add_f32_dpp v8, v8, v8 quad_perm:[1,0,3,2] row_mask:0xf bank_mask:0xf
    s_nop 1
    v_add_f32_dpp v8, v8, v8 quad_perm:[2,3,0,1] row_mask:0xf bank_mask:0xf
    s_nop 1
    v_add_f32_dpp v8, v8, v8 row_half_mirror row_mask:0xf bank_mask:0xf
    v_cvt_pk_bf16_f32 v8, v8, v8
    v_and_b32 v8, s66, v8
    v_mul_f32 v8, s64, v8
    v_cvt_pk_bf16_f32 v8, v8, v8
    v_and_b32 v8, s66, v8
    v_max_f32 v10, v4, v8
    v_sub_f32 v6, v4, v10
    v_sub_f32 v8, v8, v10
    v_mul_f32 v6, s65, v6
    v_mul_f32 v8, s65, v8
    v_exp_f32 v6, v6
    v_exp_f32 v8, v8
    v_mov_b32 v4, v10
    v_fma_f32 v5, v5, v6, v8
    v_pk_mul_f32 v[36:37], v[36:37], v[6:7] op_sel_hi:[1,0]
    v_pk_mul_f32 v[38:39], v[38:39], v[6:7] op_sel_hi:[1,0]
    v_pk_mul_f32 v[40:41], v[40:41], v[6:7] op_sel_hi:[1,0]
    v_pk_mul_f32 v[42:43], v[42:43], v[6:7] op_sel_hi:[1,0]
    v_pk_mul_f32 v[44:45], v[44:45], v[6:7] op_sel_hi:[1,0]
    v_pk_mul_f32 v[46:47], v[46:47], v[6:7] op_sel_hi:[1,0]
    v_pk_mul_f32 v[48:49], v[48:49], v[6:7] op_sel_hi:[1,0]
    v_pk_mul_f32 v[50:51], v[50:51], v[6:7] op_sel_hi:[1,0]
    v_pk_mul_f32 v[52:53], v[52:53], v[6:7] op_sel_hi:[1,0]
    v_pk_mul_f32 v[54:55], v[54:55], v[6:7] op_sel_hi:[1,0]
    v_pk_mul_f32 v[56:57], v[56:57], v[6:7] op_sel_hi:[1,0]
    v_pk_mul_f32 v[58:59], v[58:59], v[6:7] op_sel_hi:[1,0]
    s_waitcnt vmcnt(12)
    v_lshlrev_b32 v10, 16, v120
    v_and_b32 v11, s66, v120
    v_pk_fma_f32 v[36:37], v[10:11], v[8:9], v[36:37] op_sel_hi:[1,0,1]
    v_lshlrev_b32 v12, 16, v121
    v_and_b32 v13, s66, v121
    v_pk_fma_f32 v[38:39], v[12:13], v[8:9], v[38:39] op_sel_hi:[1,0,1]
    v_lshlrev_b32 v10, 16, v122
    v_and_b32 v11, s66, v122
    v_pk_fma_f32 v[40:41], v[10:11], v[8:9], v[40:41] op_sel_hi:[1,0,1]
    v_lshlrev_b32 v12, 16, v123
    v_and_b32 v13, s66, v123
    v_pk_fma_f32 v[42:43], v[12:13], v[8:9], v[42:43] op_sel_hi:[1,0,1]
    v_lshlrev_b32 v10, 16, v124
    v_and_b32 v11, s66, v124
    v_pk_fma_f32 v[44:45], v[10:11], v[8:9], v[44:45] op_sel_hi:[1,0,1]
    v_lshlrev_b32 v12, 16, v125
    v_and_b32 v13, s66, v125
    v_pk_fma_f32 v[46:47], v[12:13], v[8:9], v[46:47] op_sel_hi:[1,0,1]
    v_lshlrev_b32 v10, 16, v126
    v_and_b32 v11, s66, v126
    v_pk_fma_f32 v[48:49], v[10:11], v[8:9], v[48:49] op_sel_hi:[1,0,1]
    v_lshlrev_b32 v12, 16, v127
    v_and_b32 v13, s66, v127
    v_pk_fma_f32 v[50:51], v[12:13], v[8:9], v[50:51] op_sel_hi:[1,0,1]
    v_lshlrev_b32 v10, 16, v128
    v_and_b32 v11, s66, v128
    v_pk_fma_f32 v[52:53], v[10:11], v[8:9], v[52:53] op_sel_hi:[1,0,1]
    v_lshlrev_b32 v12, 16, v129
    v_and_b32 v13, s66, v129
    v_pk_fma_f32 v[54:55], v[12:13], v[8:9], v[54:55] op_sel_hi:[1,0,1]
    v_lshlrev_b32 v10, 16, v130
    v_and_b32 v11, s66, v130
    v_pk_fma_f32 v[56:57], v[10:11], v[8:9], v[56:57] op_sel_hi:[1,0,1]
    v_lshlrev_b32 v12, 16, v131
    v_and_b32 v13, s66, v131
    v_pk_fma_f32 v[58:59], v[12:13], v[8:9], v[58:59] op_sel_hi:[1,0,1]
    s_cmp_eq_u32 s13, 0
    s_cbranch_scc1 L_drain_done
    s_waitcnt vmcnt(9)
    v_mov_b32 v8, 0
    v_mov_b32 v9, 0
    v_dot2c_f32_bf16 v8, v84, v24
    v_dot2c_f32_bf16 v9, v85, v25
    v_dot2c_f32_bf16 v8, v86, v26
    v_dot2c_f32_bf16 v9, v87, v27
    v_dot2c_f32_bf16 v8, v88, v28
    v_dot2c_f32_bf16 v9, v89, v29
    v_dot2c_f32_bf16 v8, v90, v30
    v_dot2c_f32_bf16 v9, v91, v31
    v_dot2c_f32_bf16 v8, v92, v32
    v_dot2c_f32_bf16 v9, v93, v33
    v_dot2c_f32_bf16 v8, v94, v34
    v_dot2c_f32_bf16 v9, v95, v35
    s_nop 2
    v_add_f32 v8, v8, v9
    s_nop 1
    v_add_f32_dpp v8, v8, v8 quad_perm:[1,0,3,2] row_mask:0xf bank_mask:0xf
    s_nop 1
    v_add_f32_dpp v8, v8, v8 quad_perm:[2,3,0,1] row_mask:0xf bank_mask:0xf
    s_nop 1
    v_add_f32_dpp v8, v8, v8 row_half_mirror row_mask:0xf bank_mask:0xf
    v_cvt_pk_bf16_f32 v8, v8, v8
    v_and_b32 v8, s66, v8
    v_mul_f32 v8, s64, v8
    v_cvt_pk_bf16_f32 v8, v8, v8
    v_and_b32 v8, s66, v8
    v_max_f32 v10, v4, v8
    v_sub_f32 v6, v4, v10
    v_sub_f32 v8, v8, v10
    v_mul_f32 v6, s65, v6
    v_mul_f32 v8, s65, v8
    v_exp_f32 v6, v6
    v_exp_f32 v8, v8
    v_mov_b32 v4, v10
    v_fma_f32 v5, v5, v6, v8
    v_pk_mul_f32 v[36:37], v[36:37], v[6:7] op_sel_hi:[1,0]
    v_pk_mul_f32 v[38:39], v[38:39], v[6:7] op_sel_hi:[1,0]
    v_pk_mul_f32 v[40:41], v[40:41], v[6:7] op_sel_hi:[1,0]
    v_pk_mul_f32 v[42:43], v[42:43], v[6:7] op_sel_hi:[1,0]
    v_pk_mul_f32 v[44:45], v[44:45], v[6:7] op_sel_hi:[1,0]
    v_pk_mul_f32 v[46:47], v[46:47], v[6:7] op_sel_hi:[1,0]
    v_pk_mul_f32 v[48:49], v[48:49], v[6:7] op_sel_hi:[1,0]
    v_pk_mul_f32 v[50:51], v[50:51], v[6:7] op_sel_hi:[1,0]
    v_pk_mul_f32 v[52:53], v[52:53], v[6:7] op_sel_hi:[1,0]
    v_pk_mul_f32 v[54:55], v[54:55], v[6:7] op_sel_hi:[1,0]
    v_pk_mul_f32 v[56:57], v[56:57], v[6:7] op_sel_hi:[1,0]
    v_pk_mul_f32 v[58:59], v[58:59], v[6:7] op_sel_hi:[1,0]
    s_waitcnt vmcnt(6)
    v_lshlrev_b32 v10, 16, v132
    v_and_b32 v11, s66, v132
    v_pk_fma_f32 v[36:37], v[10:11], v[8:9], v[36:37] op_sel_hi:[1,0,1]
    v_lshlrev_b32 v12, 16, v133
    v_and_b32 v13, s66, v133
    v_pk_fma_f32 v[38:39], v[12:13], v[8:9], v[38:39] op_sel_hi:[1,0,1]
    v_lshlrev_b32 v10, 16, v134
    v_and_b32 v11, s66, v134
    v_pk_fma_f32 v[40:41], v[10:11], v[8:9], v[40:41] op_sel_hi:[1,0,1]
    v_lshlrev_b32 v12, 16, v135
    v_and_b32 v13, s66, v135
    v_pk_fma_f32 v[42:43], v[12:13], v[8:9], v[42:43] op_sel_hi:[1,0,1]
    v_lshlrev_b32 v10, 16, v136
    v_and_b32 v11, s66, v136
    v_pk_fma_f32 v[44:45], v[10:11], v[8:9], v[44:45] op_sel_hi:[1,0,1]
    v_lshlrev_b32 v12, 16, v137
    v_and_b32 v13, s66, v137
    v_pk_fma_f32 v[46:47], v[12:13], v[8:9], v[46:47] op_sel_hi:[1,0,1]
    v_lshlrev_b32 v10, 16, v138
    v_and_b32 v11, s66, v138
    v_pk_fma_f32 v[48:49], v[10:11], v[8:9], v[48:49] op_sel_hi:[1,0,1]
    v_lshlrev_b32 v12, 16, v139
    v_and_b32 v13, s66, v139
    v_pk_fma_f32 v[50:51], v[12:13], v[8:9], v[50:51] op_sel_hi:[1,0,1]
    v_lshlrev_b32 v10, 16, v140
    v_and_b32 v11, s66, v140
    v_pk_fma_f32 v[52:53], v[10:11], v[8:9], v[52:53] op_sel_hi:[1,0,1]
    v_lshlrev_b32 v12, 16, v141
    v_and_b32 v13, s66, v141
    v_pk_fma_f32 v[54:55], v[12:13], v[8:9], v[54:55] op_sel_hi:[1,0,1]
    v_lshlrev_b32 v10, 16, v142
    v_and_b32 v11, s66, v142
    v_pk_fma_f32 v[56:57], v[10:11], v[8:9], v[56:57] op_sel_hi:[1,0,1]
    v_lshlrev_b32 v12, 16, v143
    v_and_b32 v13, s66, v143
    v_pk_fma_f32 v[58:59], v[12:13], v[8:9], v[58:59] op_sel_hi:[1,0,1]
    s_waitcnt vmcnt(3)
    v_mov_b32 v8, 0
    v_mov_b32 v9, 0
    v_dot2c_f32_bf16 v8, v96, v24
    v_dot2c_f32_bf16 v9, v97, v25
    v_dot2c_f32_bf16 v8, v98, v26
    v_dot2c_f32_bf16 v9, v99, v27
    v_dot2c_f32_bf16 v8, v100, v28
    v_dot2c_f32_bf16 v9, v101, v29
    v_dot2c_f32_bf16 v8, v102, v30
    v_dot2c_f32_bf16 v9, v103, v31
    v_dot2c_f32_bf16 v8, v104, v32
    v_dot2c_f32_bf16 v9, v105, v33
    v_dot2c_f32_bf16 v8, v106, v34
    v_dot2c_f32_bf16 v9, v107, v35
    s_nop 2
    v_add_f32 v8, v8, v9
    s_nop 1
    v_add_f32_dpp v8, v8, v8 quad_perm:[1,0,3,2] row_mask:0xf bank_mask:0xf
    s_nop 1
    v_add_f32_dpp v8, v8, v8 quad_perm:[2,3,0,1] row_mask:0xf bank_mask:0xf
    s_nop 1
    v_add_f32_dpp v8, v8, v8 row_half_mirror row_mask:0xf bank_mask:0xf
    v_cvt_pk_bf16_f32 v8, v8, v8
    v_and_b32 v8, s66, v8
    v_mul_f32 v8, s64, v8
    v_cvt_pk_bf16_f32 v8, v8, v8
    v_and_b32 v8, s66, v8
    v_max_f32 v10, v4, v8
    v_sub_f32 v6, v4, v10
    v_sub_f32 v8, v8, v10
    v_mul_f32 v6, s65, v6
    v_mul_f32 v8, s65, v8
    v_exp_f32 v6, v6
    v_exp_f32 v8, v8
    v_mov_b32 v4, v10
    v_fma_f32 v5, v5, v6, v8
    v_pk_mul_f32 v[36:37], v[36:37], v[6:7] op_sel_hi:[1,0]
    v_pk_mul_f32 v[38:39], v[38:39], v[6:7] op_sel_hi:[1,0]
    v_pk_mul_f32 v[40:41], v[40:41], v[6:7] op_sel_hi:[1,0]
    v_pk_mul_f32 v[42:43], v[42:43], v[6:7] op_sel_hi:[1,0]
    v_pk_mul_f32 v[44:45], v[44:45], v[6:7] op_sel_hi:[1,0]
    v_pk_mul_f32 v[46:47], v[46:47], v[6:7] op_sel_hi:[1,0]
    v_pk_mul_f32 v[48:49], v[48:49], v[6:7] op_sel_hi:[1,0]
    v_pk_mul_f32 v[50:51], v[50:51], v[6:7] op_sel_hi:[1,0]
    v_pk_mul_f32 v[52:53], v[52:53], v[6:7] op_sel_hi:[1,0]
    v_pk_mul_f32 v[54:55], v[54:55], v[6:7] op_sel_hi:[1,0]
    v_pk_mul_f32 v[56:57], v[56:57], v[6:7] op_sel_hi:[1,0]
    v_pk_mul_f32 v[58:59], v[58:59], v[6:7] op_sel_hi:[1,0]
    s_waitcnt vmcnt(0)
    v_lshlrev_b32 v10, 16, v144
    v_and_b32 v11, s66, v144
    v_pk_fma_f32 v[36:37], v[10:11], v[8:9], v[36:37] op_sel_hi:[1,0,1]
    v_lshlrev_b32 v12, 16, v145
    v_and_b32 v13, s66, v145
    v_pk_fma_f32 v[38:39], v[12:13], v[8:9], v[38:39] op_sel_hi:[1,0,1]
    v_lshlrev_b32 v10, 16, v146
    v_and_b32 v11, s66, v146
    v_pk_fma_f32 v[40:41], v[10:11], v[8:9], v[40:41] op_sel_hi:[1,0,1]
    v_lshlrev_b32 v12, 16, v147
    v_and_b32 v13, s66, v147
    v_pk_fma_f32 v[42:43], v[12:13], v[8:9], v[42:43] op_sel_hi:[1,0,1]
    v_lshlrev_b32 v10, 16, v148
    v_and_b32 v11, s66, v148
    v_pk_fma_f32 v[44:45], v[10:11], v[8:9], v[44:45] op_sel_hi:[1,0,1]
    v_lshlrev_b32 v12, 16, v149
    v_and_b32 v13, s66, v149
    v_pk_fma_f32 v[46:47], v[12:13], v[8:9], v[46:47] op_sel_hi:[1,0,1]
    v_lshlrev_b32 v10, 16, v150
    v_and_b32 v11, s66, v150
    v_pk_fma_f32 v[48:49], v[10:11], v[8:9], v[48:49] op_sel_hi:[1,0,1]
    v_lshlrev_b32 v12, 16, v151
    v_and_b32 v13, s66, v151
    v_pk_fma_f32 v[50:51], v[12:13], v[8:9], v[50:51] op_sel_hi:[1,0,1]
    v_lshlrev_b32 v10, 16, v152
    v_and_b32 v11, s66, v152
    v_pk_fma_f32 v[52:53], v[10:11], v[8:9], v[52:53] op_sel_hi:[1,0,1]
    v_lshlrev_b32 v12, 16, v153
    v_and_b32 v13, s66, v153
    v_pk_fma_f32 v[54:55], v[12:13], v[8:9], v[54:55] op_sel_hi:[1,0,1]
    v_lshlrev_b32 v10, 16, v154
    v_and_b32 v11, s66, v154
    v_pk_fma_f32 v[56:57], v[10:11], v[8:9], v[56:57] op_sel_hi:[1,0,1]
    v_lshlrev_b32 v12, 16, v155
    v_and_b32 v13, s66, v155
    v_pk_fma_f32 v[58:59], v[12:13], v[8:9], v[58:59] op_sel_hi:[1,0,1]
L_drain_done:
    s_waitcnt vmcnt(0)
    s_mov_b32 s44, s16
    s_and_b32 s45, s17, 0xffff
    s_mov_b32 s46, 7864320
    s_mov_b32 s47, 0x20000
    v_lshrrev_b32 v10, 3, v1
    v_and_b32 v11, 7, v1
    v_mul_u32_u24 v10, 1280, v10
    v_lshl_add_u32 v10, v11, 4, v10
    s_mul_i32 s67, s53, 245760
    s_lshl_b32 s68, s54, 7
    s_add_u32 s67, s67, s68
    s_mul_i32 s68, s52, 10240
    s_add_u32 s67, s67, s68
    s_lshl_b32 s69, s52, 10
    s_add_u32 s69, s69, 10880
    s_mov_b32 s68, 0
L_dma2:
    s_add_u32 m0, s69, 0
    s_add_u32 s72, s67, 0
    buffer_load_dwordx4 v10, s[44:47], s72 offen nt lds
    s_add_u32 m0, s69, 4096
    s_add_u32 s72, s67, 40960
    buffer_load_dwordx4 v10, s[44:47], s72 offen nt lds
    s_add_u32 m0, s69, 8192
    s_add_u32 s72, s67, 81920
    buffer_load_dwordx4 v10, s[44:47], s72 offen nt lds
    s_add_u32 m0, s69, 12288
    s_add_u32 s72, s67, 122880
    buffer_load_dwordx4 v10, s[44:47], s72 offen nt lds
    s_add_u32 m0, s69, 16384
    s_add_u32 s72, s67, 163840
    buffer_load_dwordx4 v10, s[44:47], s72 offen nt lds
    s_add_u32 m0, s69, 20480
    s_add_u32 s72, s67, 204800
    buffer_load_dwordx4 v10, s[44:47], s72 offen nt lds
    s_cmp_ge_u32 s54, 2
    s_cbranch_scc1 L_dma2_done
    s_cmp_lg_u32 s68, 0
    s_cbranch_scc1 L_dma2_done
    s_mov_b32 s68, 1
    s_add_u32 s67, s67, 1024
    s_add_u32 s69, s69, 24576
    s_branch L_dma2
L_dma2_done:
    s_mov_b32 s99, -1
    s_and_b32 s67, s53, 7
    s_cmp_lg_u32 s67, s54
    s_cbranch_scc1 L_nocons
    s_cmp_lt_u32 s53, 22
    s_cbranch_scc1 L_nocons
    s_sub_u32 s99, s53, 22
    s_mov_b32 s48, s8
    s_and_b32 s49, s9, 0xffff
    s_mov_b32 s50, 1280
    s_mov_b32 s51, 0x20000
    s_lshl_b32 s67, s99, 7
    v_lshlrev_b32 v22, 2, v0
    v_min_u32 v22, 124, v22
    buffer_load_dword v23, v22, s[48:51], s67 offen
    v_lshrrev_b32 v10, 5, v0
    v_and_b32 v11, 31, v0
    v_lshlrev_b32 v92, 11, v10
    v_lshl_add_u32 v92, v11, 4, v92
    v_mul_u32_u24 v93, 1536, v10
    v_lshl_add_u32 v93, v11, 4, v93
    v_lshlrev_b32 v94, 8, v10
    v_lshl_add_u32 v94, v11, 3, v94
    s_lshl_b32 s67, s99, 14
    s_add_u32 s67, s67, 2359296
    buffer_load_dwordx4 v[60:63], v93, s[40:43], s67 offen offset:0 sc1
    buffer_load_dwordx4 v[64:67], v93, s[40:43], s67 offen offset:512 sc1
    buffer_load_dwordx4 v[68:71], v93, s[40:43], s67 offen offset:1024 sc1
L_nocons:
    v_mov_b32 v10, v4
    s_nop 1
    v_max_f32_dpp v10, v10, v10 row_ror:8 row_mask:0xf bank_mask:0xf
    v_mov_b32 v11, v10
    s_nop 1
    v_permlane16_swap_b32 v10, v11
    v_max_f32 v10, v10, v11
    v_mov_b32 v11, v10
    s_nop 1
    v_permlane32_swap_b32 v10, v11
    v_max_f32 v10, v10, v11
    v_sub_f32 v6, v4, v10
    v_mul_f32 v6, s65, v6
    v_exp_f32 v6, v6
    s_nop 0
    v_mul_f32 v5, v5, v6
    v_pk_mul_f32 v[36:37], v[36:37], v[6:7] op_sel_hi:[1,0]
    v_pk_mul_f32 v[38:39], v[38:39], v[6:7] op_sel_hi:[1,0]
    v_pk_mul_f32 v[40:41], v[40:41], v[6:7] op_sel_hi:[1,0]
    v_pk_mul_f32 v[42:43], v[42:43], v[6:7] op_sel_hi:[1,0]
    v_pk_mul_f32 v[44:45], v[44:45], v[6:7] op_sel_hi:[1,0]
    v_pk_mul_f32 v[46:47], v[46:47], v[6:7] op_sel_hi:[1,0]
    v_pk_mul_f32 v[48:49], v[48:49], v[6:7] op_sel_hi:[1,0]
    v_pk_mul_f32 v[50:51], v[50:51], v[6:7] op_sel_hi:[1,0]
    v_pk_mul_f32 v[52:53], v[52:53], v[6:7] op_sel_hi:[1,0]
    v_pk_mul_f32 v[54:55], v[54:55], v[6:7] op_sel_hi:[1,0]
    v_pk_mul_f32 v[56:57], v[56:57], v[6:7] op_sel_hi:[1,0]
    v_pk_mul_f32 v[58:59], v[58:59], v[6:7] op_sel_hi:[1,0]
    v_add_f32_dpp v5, v5, v5 row_ror:8 row_mask:0xf bank_mask:0xf
    v_mov_b32 v11, v5
    s_nop 1
    v_permlane16_swap_b32 v5, v11
    v_add_f32 v5, v5, v11
    v_mov_b32 v11, v5
    s_nop 1
    v_permlane32_swap_b32 v5, v11
    v_add_f32 v5, v5, v11
    v_add_f32_dpp v36, v36, v36 row_ror:8 row_mask:0xf bank_mask:0xf
    v_add_f32_dpp v37, v37, v37 row_ror:8 row_mask:0xf bank_mask:0xf
    v_add_f32_dpp v38, v38, v38 row_ror:8 row_mask:0xf bank_mask:0xf
    v_add_f32_dpp v39, v39, v39 row_ror:8 row_mask:0xf bank_mask:0xf
    v_add_f32_dpp v40, v40, v40 row_ror:8 row_mask:0xf bank_mask:0xf
    v_add_f32_dpp v41, v41, v41 row_ror:8 row_mask:0xf bank_mask:0xf
    v_add_f32_dpp v42, v42, v42 row_ror:8 row_mask:0xf bank_mask:0xf
    v_add_f32_dpp v43, v43, v43 row_ror:8 row_mask:0xf bank_mask:0xf
    v_add_f32_dpp v44, v44, v44 row_ror:8 row_mask:0xf bank_mask:0xf
    v_add_f32_dpp v45, v45, v45 row_ror:8 row_mask:0xf bank_mask:0xf
    v_add_f32_dpp v46, v46, v46 row_ror:8 row_mask:0xf bank_mask:0xf
    v_add_f32_dpp v47, v47, v47 row_ror:8 row_mask:0xf bank_mask:0xf
    v_add_f32_dpp v48, v48, v48 row_ror:8 row_mask:0xf bank_mask:0xf
    v_add_f32_dpp v49, v49, v49 row_ror:8 row_mask:0xf bank_mask:0xf
    v_add_f32_dpp v50, v50, v50 row_ror:8 row_mask:0xf bank_mask:0xf
    v_add_f32_dpp v51, v51, v51 row_ror:8 row_mask:0xf bank_mask:0xf
    v_add_f32_dpp v52, v52, v52 row_ror:8 row_mask:0xf bank_mask:0xf
    v_add_f32_dpp v53, v53, v53 row_ror:8 row_mask:0xf bank_mask:0xf
    v_add_f32_dpp v54, v54, v54 row_ror:8 row_mask:0xf bank_mask:0xf
    v_add_f32_dpp v55, v55, v55 row_ror:8 row_mask:0xf bank_mask:0xf
    v_add_f32_dpp v56, v56, v56 row_ror:8 row_mask:0xf bank_mask:0xf
    v_add_f32_dpp v57, v57, v57 row_ror:8 row_mask:0xf bank_mask:0xf
    v_add_f32_dpp v58, v58, v58 row_ror:8 row_mask:0xf bank_mask:0xf
    v_add_f32_dpp v59, v59, v59 row_ror:8 row_mask:0xf bank_mask:0xf
    v_permlane16_swap_b32 v36, v48
    v_permlane16_swap_b32 v37, v49
    v_permlane16_swap_b32 v38, v50
    v_permlane16_swap_b32 v39, v51
    v_permlane16_swap_b32 v40, v52
    v_permlane16_swap_b32 v41, v53
    v_permlane16_swap_b32 v42, v54
    v_permlane16_swap_b32 v43, v55
    v_permlane16_swap_b32 v44, v56
    v_permlane16_swap_b32 v45, v57
    v_permlane16_swap_b32 v46, v58
    v_permlane16_swap_b32 v47, v59
    v_add_f32 v36, v36, v48
    v_add_f32 v37, v37, v49
    v_add_f32 v38, v38, v50
    v_add_f32 v39, v39, v51
    v_add_f32 v40, v40, v52
    v_add_f32 v41, v41, v53
    v_add_f32 v42, v42, v54
    v_add_f32 v43, v43, v55
    v_add_f32 v44, v44, v56
    v_add_f32 v45, v45, v57
    v_add_f32 v46, v46, v58
    v_add_f32 v47, v47, v59
    v_permlane32_swap_b32 v36, v42
    v_permlane32_swap_b32 v37, v43
    v_permlane32_swap_b32 v38, v44
    v_permlane32_swap_b32 v39, v45
    v_permlane32_swap_b32 v40, v46
    v_permlane32_swap_b32 v41, v47
    v_add_f32 v36, v36, v42
    v_add_f32 v37, v37, v43
    v_add_f32 v38, v38, v44
    v_add_f32 v39, v39, v45
    v_add_f32 v40, v40, v46
    v_add_f32 v41, v41, v47
    s_mul_i32 s67, s52, 768
    s_add_u32 s67, s67, 2560
    v_add_u32 v11, s67, v16
    ds_write_b32 v11, v36
    v_add_u32 v11, s67, v17
    ds_write_b32 v11, v37
    v_add_u32 v11, s67, v18
    ds_write_b32 v11, v38
    v_add_u32 v11, s67, v19
    ds_write_b32 v11, v39
    v_add_u32 v11, s67, v20
    ds_write_b32 v11, v40
    v_add_u32 v11, s67, v21
    ds_write_b32 v11, v41
    v_mov_b32 v8, v10
    v_mov_b32 v9, v5
    s_lshl_b32 s67, s52, 3
    v_mov_b32 v11, s67
    ds_write_b64 v11, v[8:9] offset:5632
    s_waitcnt lgkmcnt(0)
    s_barrier
    v_cmp_gt_u32 vcc, 97, v0
    s_nop 0
    s_and_saveexec_b64 s[70:71], vcc
    s_cbranch_execz L_b_gather_done
    v_lshlrev_b32 v10, 3, v0
    v_min_u32 v10, 760, v10
    ds_read_b64 v[156:157], v10 offset:2560
    ds_read_b64 v[158:159], v10 offset:3328
    ds_read_b64 v[160:161], v10 offset:4096
    ds_read_b64 v[162:163], v10 offset:4864
    ds_read_b128 v[164:167], v3 offset:5632
    ds_read_b128 v[168:171], v3 offset:5648
    s_waitcnt lgkmcnt(0)
    v_max_f32 v172, v164, v166
    v_max3_f32 v172, v172, v168, v170
    v_sub_f32 v176, v164, v172
    v_mul_f32 v176, s65, v176
    v_exp_f32 v176, v176
    v_sub_f32 v177, v166, v172
    v_mul_f32 v177, s65, v177
    v_exp_f32 v177, v177
    v_sub_f32 v178, v168, v172
    v_mul_f32 v178, s65, v178
    v_exp_f32 v178, v178
    v_sub_f32 v179, v170, v172
    v_mul_f32 v179, s65, v179
    v_exp_f32 v179, v179
    v_mul_f32 v180, v156, v176
    v_mul_f32 v182, v157, v176
    v_mul_f32 v173, v165, v176
    v_fmac_f32 v180, v158, v177
    v_fmac_f32 v182, v159, v177
    v_fmac_f32 v173, v167, v177
    v_fmac_f32 v180, v160, v178
    v_fmac_f32 v182, v161, v178
    v_fmac_f32 v173, v169, v178
    v_fmac_f32 v180, v162, v179
    v_fmac_f32 v182, v163, v179
    v_fmac_f32 v173, v171, v179
    v_cmp_eq_u32 vcc, 96, v0
    s_nop 1
    v_cndmask_b32 v180, v180, v172, vcc
    v_cndmask_b32 v182, v182, v173, vcc
    v_mov_b32 v181, s62
    v_mov_b32 v183, s63
    v_lshlrev_b32 v11, 4, v0
    s_lshl_b32 s67, s74, 11
    s_add_u32 s67, s67, 1048576
    buffer_store_dwordx4 v[180:183], v11, s[40:43], s67 offen sc1
    v_cmp_gt_u32 vcc, 96, v0
    s_nop 0
    s_and_b64 exec, exec, vcc
    s_lshl_b32 s67, s53, 14
    s_add_u32 s67, s67, 1048576
    v_mov_b32 v12, 1536
    s_mov_b32 s73, 524288
L_poll3:
    s_mov_b32 s68, s67
    buffer_load_dwordx4 v[188:191], v11, s[40:43], s68 offen sc1
    buffer_load_dwordx4 v[156:159], v12, s[40:43], s68 offen sc1
    s_add_u32 s68, s68, 2048
    buffer_load_dwordx4 v[192:195], v11, s[40:43], s68 offen sc1
    buffer_load_dwordx4 v[160:163], v12, s[40:43], s68 offen sc1
    s_add_u32 s68, s68, 2048
    buffer_load_dwordx4 v[196:199], v11, s[40:43], s68 offen sc1
    buffer_load_dwordx4 v[164:167], v12, s[40:43], s68 offen sc1
    s_add_u32 s68, s68, 2048
    buffer_load_dwordx4 v[200:203], v11, s[40:43], s68 offen sc1
    buffer_load_dwordx4 v[168:171], v12, s[40:43], s68 offen sc1
    s_add_u32 s68, s68, 2048
    buffer_load_dwordx4 v[204:207], v11, s[40:43], s68 offen sc1
    buffer_load_dwordx4 v[172:175], v12, s[40:43], s68 offen sc1
    s_add_u32 s68, s68, 2048
    buffer_load_dwordx4 v[208:211], v11, s[40:43], s68 offen sc1
    buffer_load_dwordx4 v[176:179], v12, s[40:43], s68 offen sc1
    s_add_u32 s68, s68, 2048
    buffer_load_dwordx4 v[212:215], v11, s[40:43], s68 offen sc1
    buffer_load_dwordx4 v[180:183], v12, s[40:43], s68 offen sc1
    s_add_u32 s68, s68, 2048
    buffer_load_dwordx4 v[216:219], v11, s[40:43], s68 offen sc1
    buffer_load_dwordx4 v[184:187], v12, s[40:43], s68 offen sc1
    s_waitcnt vmcnt(0)
L_poll3_chk:
    v_xor_b32 v221, s62, v189
    v_xor_b32 v222, s63, v191
    v_or_b32 v220, v221, v222
    v_xor_b32 v221, s62, v193
    v_xor_b32 v222, s63, v195
    v_or3_b32 v220, v220, v221, v222
    v_xor_b32 v221, s62, v197
    v_xor_b32 v222, s63, v199
    v_or3_b32 v220, v220, v221, v222
    v_xor_b32 v221, s62, v201
    v_xor_b32 v222, s63, v203
    v_or3_b32 v220, v220, v221, v222
    v_xor_b32 v221, s62, v205
    v_xor_b32 v222, s63, v207
    v_or3_b32 v220, v220, v221, v222
    v_xor_b32 v221, s62, v209
    v_xor_b32 v222, s63, v211
    v_or3_b32 v220, v220, v221, v222
    v_xor_b32 v221, s62, v213
    v_xor_b32 v222, s63, v215
    v_or3_b32 v220, v220, v221, v222
    v_xor_b32 v221, s62, v217
    v_xor_b32 v222, s63, v219
    v_or3_b32 v220, v220, v221, v222
    v_xor_b32 v221, s62, v157
    v_xor_b32 v222, s63, v159
    v_or3_b32 v220, v220, v221, v222
    v_xor_b32 v221, s62, v161
    v_xor_b32 v222, s63, v163
    v_or3_b32 v220, v220, v221, v222
    v_xor_b32 v221, s62, v165
    v_xor_b32 v222, s63, v167
    v_or3_b32 v220, v220, v221, v222
    v_xor_b32 v221, s62, v169
    v_xor_b32 v222, s63, v171
    v_or3_b32 v220, v220, v221, v222
    v_xor_b32 v221, s62, v173
    v_xor_b32 v222, s63, v175
    v_or3_b32 v220, v220, v221, v222
    v_xor_b32 v221, s62, v177
    v_xor_b32 v222, s63, v179
    v_or3_b32 v220, v220, v221, v222
    v_xor_b32 v221, s62, v181
    v_xor_b32 v222, s63, v183
    v_or3_b32 v220, v220, v221, v222
    v_xor_b32 v221, s62, v185
    v_xor_b32 v222, s63, v187
    v_or3_b32 v220, v220, v221, v222
    v_cmp_eq_u32 vcc, 0, v220
    s_nop 0
    s_cmp_eq_u64 vcc, exec
    s_cbranch_scc1 L_poll3_ok
    s_sub_u32 s73, s73, 1
    s_cmp_lg_u32 s73, 0
    s_cbranch_scc1 L_poll3
L_poll3_ok:
    v_max3_f32 v220, v156, v160, v164
    v_max3_f32 v220, v220, v168, v172
    v_max3_f32 v220, v220, v176, v180
    v_max_f32 v220, v220, v184
    v_sub_f32 v156, v156, v220
    v_mul_f32 v156, s65, v156
    v_exp_f32 v156, v156
    v_sub_f32 v160, v160, v220
    v_mul_f32 v160, s65, v160
    v_exp_f32 v160, v160
    v_sub_f32 v164, v164, v220
    v_mul_f32 v164, s65, v164
    v_exp_f32 v164, v164
    v_sub_f32 v168, v168, v220
    v_mul_f32 v168, s65, v168
    v_exp_f32 v168, v168
    v_sub_f32 v172, v172, v220
    v_mul_f32 v172, s65, v172
    v_exp_f32 v172, v172
    v_sub_f32 v176, v176, v220
    v_mul_f32 v176, s65, v176
    v_exp_f32 v176, v176
    v_sub_f32 v180, v180, v220
    v_mul_f32 v180, s65, v180
    v_exp_f32 v180, v180
    v_sub_f32 v184, v184, v220
    v_mul_f32 v184, s65, v184
    v_exp_f32 v184, v184
    v_mul_f32 v221, v156, v158
    v_mul_f32 v222, v156, v188
    v_mul_f32 v223, v156, v190
    v_fmac_f32 v221, v160, v162
    v_fmac_f32 v222, v160, v192
    v_fmac_f32 v223, v160, v194
    v_fmac_f32 v221, v164, v166
    v_fmac_f32 v222, v164, v196
    v_fmac_f32 v223, v164, v198
    v_fmac_f32 v221, v168, v170
    v_fmac_f32 v222, v168, v200
    v_fmac_f32 v223, v168, v202
    v_fmac_f32 v221, v172, v174
    v_fmac_f32 v222, v172, v204
    v_fmac_f32 v223, v172, v206
    v_fmac_f32 v221, v176, v178
    v_fmac_f32 v222, v176, v208
    v_fmac_f32 v223, v176, v210
    v_fmac_f32 v221, v180, v182
    v_fmac_f32 v222, v180, v212
    v_fmac_f32 v223, v180, v214
    v_fmac_f32 v221, v184, v186
    v_fmac_f32 v222, v184, v216
    v_fmac_f32 v223, v184, v218
    v_rcp_f32 v226, v221
    s_nop 0
    v_mul_f32 v224, v222, v226
    v_fma_f32 v227, -v224, v221, v222
    v_fma_f32 v224, v227, v226, v224
    v_rcp_f32 v226, v221
    s_nop 0
    v_mul_f32 v225, v223, v226
    v_fma_f32 v227, -v225, v221, v223
    v_fma_f32 v225, v227, v226, v225
    v_cvt_pk_bf16_f32 v226, v224, v225
    v_lshlrev_b32 v10, 2, v0
    ds_write_b32 v10, v226 offset:6336
L_b_gather_done:
    s_mov_b64 exec, -1
    v_lshrrev_b32 v10, 4, v1
    v_and_b32 v11, 15, v1
    v_lshrrev_b32 v12, 2, v11
    v_lshl_add_u32 v12, v10, 3, v12
    v_lshlrev_b32 v226, 7, v12
    v_and_b32 v12, 3, v11
    v_lshl_add_u32 v226, v12, 3, v226
    s_lshl_b32 s67, s52, 5
    v_add_u32 v226, s67, v226
    v_lshlrev_b32 v227, 4, v10
    s_lshl_b32 s69, s54, 5
    s_add_u32 s69, s69, s53
    s_lshl_b32 s69, s69, 9
    s_add_u32 s69, s69, 2097152
    s_lshl_b32 s72, s52, 7
    v_lshlrev_b32 v228, 3, v1
    v_add_u32 v228, s72, v228
    s_mov_b32 s72, 0
    s_waitcnt vmcnt(0) lgkmcnt(0)
    s_barrier
    ds_read_b128 v[156:159], v227 offset:6336
    ds_read_b128 v[160:163], v227 offset:6400
    ds_read_b128 v[164:167], v227 offset:6464
    ds_read_b128 v[168:171], v227 offset:6528
    ds_read_b128 v[172:175], v227 offset:6592
    ds_read_b128 v[176:179], v227 offset:6656
L_btile:
    ds_read_b64_tr_b16 v[180:181], v226 offset:10880
    ds_read_b64_tr_b16 v[182:183], v226 offset:11392
    ds_read_b64_tr_b16 v[184:185], v226 offset:14976
    ds_read_b64_tr_b16 v[186:187], v226 offset:15488
    ds_read_b64_tr_b16 v[188:189], v226 offset:19072
    ds_read_b64_tr_b16 v[190:191], v226 offset:19584
    ds_read_b64_tr_b16 v[192:193], v226 offset:23168
    ds_read_b64_tr_b16 v[194:195], v226 offset:23680
    ds_read_b64_tr_b16 v[196:197], v226 offset:27264
    ds_read_b64_tr_b16 v[198:199], v226 offset:27776
    ds_read_b64_tr_b16 v[200:201], v226 offset:31360
    ds_read_b64_tr_b16 v[202:203], v226 offset:31872
    s_waitcnt lgkmcnt(0)
    v_mfma_f32_16x16x32_bf16 v[216:219], v[156:159], v[180:183], 0
    v_mfma_f32_16x16x32_bf16 v[216:219], v[160:163], v[184:187], v[216:219]
    v_mfma_f32_16x16x32_bf16 v[216:219], v[164:167], v[188:191], v[216:219]
    v_mfma_f32_16x16x32_bf16 v[216:219], v[168:171], v[192:195], v[216:219]
    v_mfma_f32_16x16x32_bf16 v[216:219], v[172:175], v[196:199], v[216:219]
    v_mfma_f32_16x16x32_bf16 v[216:219], v[176:179], v[200:203], v[216:219]
    v_mov_b32 v221, s62
    v_mov_b32 v223, s63
    s_nop 7
    s_nop 1
    v_mov_b32 v220, v216
    v_mov_b32_dpp v222, v216 quad_perm:[1,0,3,2] row_mask:0xf bank_mask:0xf
    s_mov_b64 exec, 0x5555
    buffer_store_dwordx4 v[220:223], v228, s[40:43], s69 offen sc1
    s_mov_b64 exec, -1
    s_cmp_ge_u32 s54, 2
    s_cbranch_scc1 L_b_pub_done
    s_cmp_lg_u32 s72, 0
    s_cbranch_scc1 L_b_pub_done
    s_mov_b32 s72, 1
    v_add_u32 v226, 24576, v226
    s_add_u32 s69, s69, 131072
    s_branch L_btile
L_b_pub_done:
    s_cmp_eq_u32 s99, -1
    s_cbranch_scc1 L_fin
    s_mov_b32 s73, 524288
    s_waitcnt vmcnt(63)
    s_branch L_poll4_chk
L_poll4:
    s_lshl_b32 s67, s99, 14
    s_add_u32 s67, s67, 2359296
    buffer_load_dwordx4 v[60:63], v93, s[40:43], s67 offen offset:0 sc1
    buffer_load_dwordx4 v[64:67], v93, s[40:43], s67 offen offset:512 sc1
    buffer_load_dwordx4 v[68:71], v93, s[40:43], s67 offen offset:1024 sc1
    s_waitcnt vmcnt(0)
L_poll4_chk:
    v_xor_b32 v221, s62, v61
    v_xor_b32 v222, s63, v63
    v_or_b32 v220, v221, v222
    v_xor_b32 v221, s62, v65
    v_xor_b32 v222, s63, v67
    v_or3_b32 v220, v220, v221, v222
    v_xor_b32 v221, s62, v69
    v_xor_b32 v222, s63, v71
    v_or3_b32 v220, v220, v221, v222
    v_cmp_eq_u32 vcc, 0, v220
    s_nop 0
    s_cmp_eq_u64 vcc, exec
    s_cbranch_scc1 L_poll4_ok
    s_sub_u32 s73, s73, 1
    s_cmp_lg_u32 s73, 0
    s_cbranch_scc1 L_poll4
L_poll4_ok:
    v_add_f32 v224, v60, v64
    v_add_f32 v225, v62, v66
    v_add_f32 v224, v224, v68
    v_add_f32 v225, v225, v70
    ds_write_b64 v94, v[224:225] offset:8768
    s_lshl_b32 s67, s99, 14
    s_add_u32 s67, s67, 2097152
    buffer_load_dwordx4 v[156:159], v92, s[40:43], s67 offen offset:0 sc1
    buffer_load_dwordx4 v[160:163], v92, s[40:43], s67 offen offset:512 sc1
    buffer_load_dwordx4 v[164:167], v92, s[40:43], s67 offen offset:1024 sc1
    buffer_load_dwordx4 v[168:171], v92, s[40:43], s67 offen offset:1536 sc1
    s_waitcnt lgkmcnt(0)
    s_barrier
    v_and_b32 v10, 31, v0
    v_lshlrev_b32 v10, 3, v10
    ds_read_b64 v[100:101], v10 offset:8768
    ds_read_b64 v[102:103], v10 offset:9024
    ds_read_b64 v[104:105], v10 offset:9280
    ds_read_b64 v[106:107], v10 offset:9536
    ds_read_b64 v[108:109], v10 offset:9792
    ds_read_b64 v[110:111], v10 offset:10048
    ds_read_b64 v[112:113], v10 offset:10304
    ds_read_b64 v[114:115], v10 offset:10560
    s_waitcnt lgkmcnt(0)
    v_add_f32 v96, v100, v102
    v_add_f32 v96, v96, v104
    v_add_f32 v96, v96, v106
    v_add_f32 v96, v96, v108
    v_add_f32 v96, v96, v110
    v_add_f32 v96, v96, v112
    v_add_f32 v96, v96, v114
    v_cvt_pk_bf16_f32 v96, v96, v96
    v_and_b32 v96, s66, v96
    v_mul_f32 v98, s65, v96
    v_sub_f32 v98, 0, v98
    v_exp_f32 v98, v98
    s_nop 0
    v_add_f32 v98, 1.0, v98
    v_rcp_f32 v99, v98
    s_nop 0
    v_mul_f32 v96, v96, v99
    v_cvt_pk_bf16_f32 v96, v96, v96
    v_and_b32 v96, s66, v96
    v_add_f32 v97, v101, v103
    v_add_f32 v97, v97, v105
    v_add_f32 v97, v97, v107
    v_add_f32 v97, v97, v109
    v_add_f32 v97, v97, v111
    v_add_f32 v97, v97, v113
    v_add_f32 v97, v97, v115
    v_cvt_pk_bf16_f32 v97, v97, v97
    v_and_b32 v97, s66, v97
    v_mul_f32 v98, s65, v97
    v_sub_f32 v98, 0, v98
    v_exp_f32 v98, v98
    s_nop 0
    v_add_f32 v98, 1.0, v98
    v_rcp_f32 v99, v98
    s_nop 0
    v_mul_f32 v97, v97, v99
    v_cvt_pk_bf16_f32 v97, v97, v97
    v_and_b32 v97, s66, v97
    s_mov_b32 s73, 524288
    s_waitcnt vmcnt(0)
    s_branch L_poll5_chk
L_poll5:
    s_lshl_b32 s67, s99, 14
    s_add_u32 s67, s67, 2097152
    buffer_load_dwordx4 v[156:159], v92, s[40:43], s67 offen offset:0 sc1
    buffer_load_dwordx4 v[160:163], v92, s[40:43], s67 offen offset:512 sc1
    buffer_load_dwordx4 v[164:167], v92, s[40:43], s67 offen offset:1024 sc1
    buffer_load_dwordx4 v[168:171], v92, s[40:43], s67 offen offset:1536 sc1
    s_waitcnt vmcnt(0)
L_poll5_chk:
    v_xor_b32 v221, s62, v157
    v_xor_b32 v222, s63, v159
    v_or_b32 v220, v221, v222
    v_xor_b32 v221, s62, v161
    v_xor_b32 v222, s63, v163
    v_or3_b32 v220, v220, v221, v222
    v_xor_b32 v221, s62, v165
    v_xor_b32 v222, s63, v167
    v_or3_b32 v220, v220, v221, v222
    v_xor_b32 v221, s62, v169
    v_xor_b32 v222, s63, v171
    v_or3_b32 v220, v220, v221, v222
    v_cmp_eq_u32 vcc, 0, v220
    s_nop 0
    s_cmp_eq_u64 vcc, exec
    s_cbranch_scc1 L_poll5_ok
    s_sub_u32 s73, s73, 1
    s_cmp_lg_u32 s73, 0
    s_cbranch_scc1 L_poll5
L_poll5_ok:
    v_add_f32 v224, v156, v160
    v_add_f32 v225, v158, v162
    v_add_f32 v226, v164, v168
    v_add_f32 v227, v166, v170
    v_add_f32 v224, v224, v226
    v_add_f32 v225, v225, v227
    ds_write_b64 v94, v[224:225] offset:6720
    s_waitcnt lgkmcnt(0)
    s_barrier
    s_cmp_lg_u32 s52, 0
    s_cbranch_scc1 L_fin
    s_mov_b32 exec_lo, -1
    s_mov_b32 exec_hi, 0
    s_mov_b32 s48, s26
    s_and_b32 s49, s27, 0xffff
    s_mov_b32 s50, 1280
    s_mov_b32 s51, 0x20000
    s_lshl_b32 s67, s99, 7
    v_lshlrev_b32 v11, 2, v0
    ds_read_b64 v[156:157], v10 offset:6720
    ds_read_b64 v[158:159], v10 offset:6976
    ds_read_b64 v[160:161], v10 offset:7232
    ds_read_b64 v[162:163], v10 offset:7488
    ds_read_b64 v[164:165], v10 offset:7744
    ds_read_b64 v[166:167], v10 offset:8000
    ds_read_b64 v[168:169], v10 offset:8256
    ds_read_b64 v[170:171], v10 offset:8512
    s_waitcnt lgkmcnt(0)
    v_add_f32 v172, v156, v158
    v_add_f32 v174, v160, v162
    v_add_f32 v176, v164, v166
    v_add_f32 v178, v168, v170
    v_add_f32 v172, v172, v174
    v_add_f32 v176, v176, v178
    v_add_f32 v172, v172, v176
    v_cvt_pk_bf16_f32 v172, v172, v172
    v_and_b32 v172, s66, v172
    v_mul_f32 v172, v172, v96
    v_cvt_pk_bf16_f32 v172, v172, v172
    v_and_b32 v172, s66, v172
    v_add_f32 v173, v157, v159
    v_add_f32 v175, v161, v163
    v_add_f32 v177, v165, v167
    v_add_f32 v179, v169, v171
    v_add_f32 v173, v173, v175
    v_add_f32 v177, v177, v179
    v_add_f32 v173, v173, v177
    v_cvt_pk_bf16_f32 v173, v173, v173
    v_and_b32 v173, s66, v173
    v_mul_f32 v173, v173, v97
    v_cvt_pk_bf16_f32 v173, v173, v173
    v_and_b32 v173, s66, v173
    v_lshlrev_b32 v168, 16, v23
    v_and_b32 v169, s66, v23
    v_add_f32 v172, v172, v168
    v_add_f32 v173, v173, v169
    v_cvt_pk_bf16_f32 v172, v172, v173
    buffer_store_dword v172, v11, s[48:51], s67 offen
    s_cmp_lg_u32 s99, 0
    s_cbranch_scc1 L_fin
    s_mov_b64 exec, 1
    v_mov_b32 v158, s62
    v_mov_b32 v159, s63
    buffer_store_dwordx2 v[158:159], v3, s[40:43], 0 offen offset:0
L_fin:
L_end:
    s_endpgm
L_code_end:
.section .rodata,"a"
.p2align 6
.amdhsa_kernel recurrent_scan__mha_block_cached__glu_gated_reglu__decode_kernel
  .amdhsa_next_free_vgpr 256
  .amdhsa_next_free_sgpr 102
  .amdhsa_accum_offset 256
  .amdhsa_group_segment_fixed_size 0
  .amdhsa_kernarg_size 96
  .amdhsa_user_sgpr_count 2
  .amdhsa_user_sgpr_kernarg_segment_ptr 1
  .amdhsa_system_sgpr_workgroup_id_x 1
  .amdhsa_float_denorm_mode_32 3
.end_amdhsa_kernel
```
